```python
import torch

def _softmax(x, axis=-1):
    return torch.softmax(x, dim=axis)
def _gelu(x):
    return torch.nn.functional.gelu(x, approximate="tanh")
def _silu(x):
    return torch.nn.functional.silu(x)
def _sigmoid(x):
    return torch.sigmoid(x)
def _layernorm(x, axis=-1, eps=1e-5):
    m = x.mean(dim=axis, keepdim=True)
    v = x.var(dim=axis, keepdim=True, unbiased=False)
    return (x - m) / torch.sqrt(v + eps)
def _scatter_add(tgt, idx, src, axis=0):
    return tgt.clone().index_add_(axis, idx, src)
def _segment_sum(src, seg, n):
    out = torch.zeros((n,) + src.shape[1:], dtype=src.dtype)
    return out.index_add_(0, seg, src)
def _pad(x, pw):
    flat = tuple(v for pair in reversed(pw) for v in pair)
    return torch.nn.functional.pad(x, flat)

kernel_name = 'recurrent_scan__ssm_conv_s4__mixer_channel_mlp__prompt'

def setup_inputs():

    _w = (lambda a: (lambda t: t.to(torch.bfloat16) if t.is_floating_point() else t)(torch.as_tensor(a)))
    def _A_setup():
        B, L, D, N = 1, 2048, 512, 128
        A_re = -(lambda _x: torch.exp(torch.as_tensor(_x)))((lambda *s: torch.randn(*s, dtype=torch.bfloat16) * 3.2)(D, N))
        A_im = torch.pi * (lambda *s: torch.randn(*s, dtype=torch.bfloat16) * 0.05)(D, N)
        B_re = (lambda *s: torch.randn(*s, dtype=torch.bfloat16) * 0.1)(D, N)
        B_im = (lambda *s: torch.randn(*s, dtype=torch.bfloat16) * 0.1)(D, N)
        C_re = (lambda *s: torch.randn(*s, dtype=torch.bfloat16) * 0.1)(D, N)
        C_im = (lambda *s: torch.randn(*s, dtype=torch.bfloat16) * 0.2)(D, N)
        log_dt = (lambda *s: torch.randn(*s, dtype=torch.bfloat16) * 0.05)(D) * 0.5 - 4.0
        Dskip = (lambda *s: torch.randn(*s, dtype=torch.bfloat16) * 0.05)(D)
        return {
            "u": _w((lambda *s: torch.randn(*s, dtype=torch.bfloat16) * 0.05)(B, L, D)),
            "A_re": _w(A_re),
            "A_im": _w(A_im),
            "B_re": _w(B_re),
            "B_im": _w(B_im),
            "C_re": _w(C_re),
            "C_im": _w(C_im),
            "log_dt": _w(log_dt),
            "Dskip": _w(Dskip),
        }
    _A_in = _A_setup()

    def _B_setup():
        B, S, D, F = 1, 2048, 512, 1792
        return {
            "x": _w((lambda *s: torch.randn(*s, dtype=torch.bfloat16) * 0.05)(B, S, D)),
            "w1": _w((lambda *s: torch.randn(*s, dtype=torch.bfloat16) * 1.6)(D, F) * (D ** -0.5)),
            "b1": _w((lambda *s: torch.randn(*s, dtype=torch.bfloat16) * 0.8)(F)),
            "w2": _w((lambda *s: torch.randn(*s, dtype=torch.bfloat16) * 0.05)(F, D) * (F ** -0.5)),
            "b2": _w((lambda *s: torch.randn(*s, dtype=torch.bfloat16) * 0.05)(D)),
        }
    _B_in = _B_setup()

    return {
        "A_u": _A_in["u"],
        "A_A_re": _A_in["A_re"],
        "A_A_im": _A_in["A_im"],
        "A_B_re": _A_in["B_re"],
        "A_B_im": _A_in["B_im"],
        "A_C_re": _A_in["C_re"],
        "A_C_im": _A_in["C_im"],
        "A_log_dt": _A_in["log_dt"],
        "A_Dskip": _A_in["Dskip"],
        "B_x": _B_in["x"],
        "B_w1": _B_in["w1"],
        "B_b1": _B_in["b1"],
        "B_w2": _B_in["w2"],
        "B_b2": _B_in["b2"],
    }

def reference(A_u, A_A_re, A_A_im, A_B_re, A_B_im, A_C_re, A_C_im, A_log_dt, A_Dskip, B_x, B_w1, B_b1, B_w2, B_b2):
    def _A_ref(u, A_re, A_im, B_re, B_im, C_re, C_im, log_dt, Dskip):
        Bsz, L, D = u.shape
        dt = torch.exp(log_dt)[:, None]
        A = A_re + 1j * A_im
        Bc = B_re + 1j * B_im
        Cc = C_re + 1j * C_im
        logdA = dt * A
        dB = dt * Bc
        l = (lambda x, dt: x.to(dt))(torch.arange(L), A_re.dtype)
        P = torch.exp(logdA[:, :, None] * l[None, None, :])
        K = torch.einsum("dn,dnl,dn->dl", Cc, P, dB).real
        L2 = 2 * L
        Kp = _pad(K, ((0, 0), (0, L)))
        up = (lambda x, *d: x.permute(*d))(u, 0, 2, 1)
        up = _pad(up, ((0, 0), (0, 0), (0, L)))
        Kf = (lambda x, axes=(-2,-1): torch.fft.rfft2(x.float(), dim=axes))(Kp[:, None, :], axes=(-2, -1))
        Uf = (lambda x, axes=(-2,-1): torch.fft.rfft2(x.float(), dim=axes))(up[:, :, None, :], axes=(-2, -1))
        Yf = Uf * Kf[None, :, :, :]
        y = (lambda x, s, axes=(-2,-1): torch.fft.irfft2(x, s=s, dim=axes).to(torch.bfloat16))(Yf, (1, L2), axes=(-2, -1))[:, :, 0, :L]
        y = (lambda x, *d: x.permute(*d))(y, 0, 2, 1) + u * Dskip[None, None, :]
        return y

    def _B_ref(x, w1, b1, w2, b2):
        y = _layernorm(x, axis=-1)
        h = _gelu(torch.einsum("bsd,df->bsf", y, w1) + b1)
        return torch.einsum("bsf,fd->bsd", h, w2) + b2

    x = A_u
    xn = _layernorm(x, axis=-1)
    s = _A_ref(xn, A_A_re, A_A_im, A_B_re, A_B_im, A_C_re, A_C_im, A_log_dt, A_Dskip)
    g = _silu(_B_ref(xn, B_w1, B_b1, B_w2, B_b2))
    return x + s * g
```

```asm
; @launch kernel=recurrent_scan__ssm_conv_s4__mixer_channel_mlp__prompt_kernel grid=(512,1,1) block=(256,1,1) lds=81920
.amdgcn_target "amdgcn-amd-amdhsa--gfx950"
.text
.globl recurrent_scan__ssm_conv_s4__mixer_channel_mlp__prompt_kernel
.p2align 8
.type recurrent_scan__ssm_conv_s4__mixer_channel_mlp__prompt_kernel,@function
recurrent_scan__ssm_conv_s4__mixer_channel_mlp__prompt_kernel:
    s_cmp_ge_u32 s2, 512
    s_cbranch_scc1 L_exit
    s_load_dwordx16 s[16:31], s[0:1], 0
    s_load_dwordx16 s[32:47], s[0:1], 64
    s_load_dwordx2 s[48:49], s[0:1], 128
    s_getpc_b64 s[52:53]
    s_lshr_b32 s54, s2, 3
    s_and_b32 s54, s54, 15
    s_lshl_b32 s54, s54, 12
    v_lshl_add_u32 v4, v0, 4, s54
    v_min_u32 v4, 26320, v4
    global_load_dwordx4 v[252:255], v4, s[52:53]
    v_lshrrev_b32 v1, 6, v0
    s_nop 0
    v_readfirstlane_b32 s3, v1
    v_and_b32 v1, 63, v0
    v_mov_b32 v3, 0
    s_waitcnt lgkmcnt(0)
    s_mov_b32 s4, s48
    s_mov_b32 s5, s49
    s_mov_b32 s6, 0x10000000
    s_mov_b32 s7, 0x20000
    buffer_load_dword v2, v3, s[4:7], 0 offen offset:0 sc1
    s_cmp_ge_u32 s2, 256
    s_cbranch_scc1 L_role_A
    s_mov_b32 s8, s16
    s_mov_b32 s9, s17
    s_mov_b32 s10, 2097152
    s_mov_b32 s11, 0x20000
    s_and_b32 s53, s2, 7
    s_lshl_b32 s53, s53, 5
    s_lshr_b32 s60, s2, 3
    s_add_u32 s53, s53, s60
    s_lshl_b32 s61, s53, 3
    s_lshl_b32 s62, s3, 1
    s_add_u32 s61, s61, s62
    s_lshl_b32 s62, s61, 10
    v_lshlrev_b32 v8, 4, v1
    buffer_load_dwordx4 v[18:21], v8, s[8:11], s62 offen
    buffer_load_dwordx4 v[22:25], v8, s[8:11], s62 offen offset:1024
    s_and_b32 s59, s2, 7
    s_lshl_b32 s59, s59, 5
    s_lshr_b32 s60, s2, 3
    s_add_u32 s59, s59, s60
    s_lshr_b32 s57, s3, 1
    s_and_b32 s58, s3, 1
    s_lshl_b32 s63, s59, 1
    s_add_u32 s63, s63, s57
    s_lshl_b32 s60, s63, 8
    s_lshl_b32 s62, s58, 7
    s_add_u32 s62, s62, s60
    v_lshl_add_u32 v4, v1, 1, s62
    v_xor_b32 v6, 128, v4
    s_lshl_b32 s60, s63, 1
    v_mov_b32 v5, s60
    v_mov_b32 v36, v4
    v_mov_b32 v37, v5
    v_mov_b32 v38, v6
    v_and_b32 v11, 15, v1
    v_lshrrev_b32 v12, 4, v1
    v_lshlrev_b32 v14, 4, v0
    s_lshl_b32 s60, s3, 11
    s_add_u32 s60, s60, 73728
    v_lshl_add_u32 v65, v1, 5, s60
    v_lshlrev_b32 v64, 2, v0
    v_add_u32 v64, 73728, v64
    s_mov_b32 s70, 0xffff0000
    s_mov_b32 s71, 0xffff0000
    s_waitcnt vmcnt(0)
    global_load_ushort v26, v36, s[18:19]
    global_load_ushort v27, v36, s[20:21]
    global_load_ushort v28, v36, s[22:23]
    global_load_ushort v29, v36, s[24:25]
    global_load_ushort v30, v36, s[26:27]
    global_load_ushort v31, v36, s[28:29]
    global_load_ushort v32, v38, s[22:23]
    global_load_ushort v33, v38, s[24:25]
    global_load_ushort v34, v38, s[26:27]
    global_load_ushort v35, v38, s[28:29]
    global_load_ushort v9, v37, s[30:31]
    global_load_ushort v10, v37, s[32:33]
    v_lshlrev_b32 v70, 16, v18
    v_lshlrev_b32 v71, 16, v22
    v_and_b32 v72, 0xffff0000, v18
    v_and_b32 v73, 0xffff0000, v22
    v_readfirstlane_b32 s64, v70
    v_readfirstlane_b32 s65, v71
    v_lshlrev_b32 v74, 16, v19
    v_lshlrev_b32 v75, 16, v23
    v_and_b32 v76, 0xffff0000, v19
    v_and_b32 v77, 0xffff0000, v23
    v_lshlrev_b32 v78, 16, v20
    v_lshlrev_b32 v79, 16, v24
    v_and_b32 v80, 0xffff0000, v20
    v_and_b32 v81, 0xffff0000, v24
    v_lshlrev_b32 v82, 16, v21
    v_lshlrev_b32 v83, 16, v25
    v_and_b32 v84, 0xffff0000, v21
    v_and_b32 v85, 0xffff0000, v25
    v_readfirstlane_b32 s50, v2
    s_nop 0
    s_mul_i32 s50, s50, 0x9E3779B1
    s_add_u32 s50, s50, 0x7F4A7C15
    s_xor_b32 s51, s50, 0x5bd1e995
    v_subrev_f32 v86, s64, v70
    v_subrev_f32 v87, s65, v71
    v_subrev_f32 v88, s64, v72
    v_subrev_f32 v89, s65, v73
    v_subrev_f32 v90, s64, v74
    v_subrev_f32 v91, s65, v75
    v_subrev_f32 v92, s64, v76
    v_subrev_f32 v93, s65, v77
    v_subrev_f32 v94, s64, v78
    v_subrev_f32 v95, s65, v79
    v_subrev_f32 v96, s64, v80
    v_subrev_f32 v97, s65, v81
    v_subrev_f32 v98, s64, v82
    v_subrev_f32 v99, s65, v83
    v_subrev_f32 v100, s64, v84
    v_subrev_f32 v101, s65, v85
    v_add_f32 v102, v86, v88
    v_add_f32 v106, v90, v92
    v_mul_f32 v104, v86, v86
    v_mul_f32 v108, v88, v88
    v_add_f32 v103, v87, v89
    v_add_f32 v107, v91, v93
    v_mul_f32 v105, v87, v87
    v_mul_f32 v109, v89, v89
    v_fmac_f32 v104, v90, v90
    v_fmac_f32 v105, v91, v91
    v_fmac_f32 v108, v92, v92
    v_fmac_f32 v109, v93, v93
    v_add_f32 v102, v102, v94
    v_fmac_f32 v104, v94, v94
    v_add_f32 v103, v103, v95
    v_fmac_f32 v105, v95, v95
    v_add_f32 v106, v106, v96
    v_fmac_f32 v108, v96, v96
    v_add_f32 v107, v107, v97
    v_fmac_f32 v109, v97, v97
    v_add_f32 v102, v102, v98
    v_fmac_f32 v104, v98, v98
    v_add_f32 v103, v103, v99
    v_fmac_f32 v105, v99, v99
    v_add_f32 v106, v106, v100
    v_fmac_f32 v108, v100, v100
    v_add_f32 v107, v107, v101
    v_fmac_f32 v109, v101, v101
    v_add_f32 v102, v102, v106
    v_add_f32 v104, v104, v108
    v_add_f32 v103, v103, v107
    v_add_f32 v105, v105, v109
    v_mov_b32 v111, s64
    s_mov_b64 exec, s[70:71]
    v_mov_b32 v111, s65
    s_mov_b64 exec, -1
    v_permlane16_swap_b32 v102, v103
    v_permlane16_swap_b32 v104, v105
    v_add_f32 v102, v102, v103
    v_add_f32 v104, v104, v105
    s_nop 1
    v_permlane32_swap_b32 v102, v104
    v_add_f32 v102, v102, v104
    s_nop 1
    v_add_f32_dpp v102, v102, v102 quad_perm:[1,0,3,2] row_mask:0xf bank_mask:0xf
    s_nop 1
    v_add_f32_dpp v102, v102, v102 quad_perm:[2,3,0,1] row_mask:0xf bank_mask:0xf
    s_nop 1
    v_add_f32_dpp v102, v102, v102 row_half_mirror row_mask:0xf bank_mask:0xf
    s_nop 1
    v_add_f32_dpp v102, v102, v102 row_mirror row_mask:0xf bank_mask:0xf
    v_mov_b32 v110, v102
    s_nop 1
    v_permlane32_swap_b32 v102, v110
    v_mul_f32 v102, 0x3b000000, v102
    v_mul_f32 v110, 0x3b000000, v110
    v_fma_f32 v110, -v102, v102, v110
    v_max_f32 v110, 0, v110
    v_add_f32 v102, v111, v102
    v_cvt_pk_bf16_f32 v5, v102, v110
    v_lshlrev_b32 v112, 16, v5
    v_and_b32 v5, 0xffff0000, v5
    v_add_f32 v4, 0x3727c5ac, v5
    v_cvt_pk_bf16_f32 v4, v4, v4
    v_lshlrev_b32 v4, 16, v4
    v_sqrt_f32 v4, v4
    s_nop 0
    v_cvt_pk_bf16_f32 v4, v4, v4
    v_lshlrev_b32 v114, 16, v4
    v_rcp_f32 v113, v114
    v_sub_f32 v6, v102, v112
    v_mul_f32 v7, v112, -v113
    v_readlane_b32 s68, v113, 0
    v_readlane_b32 s69, v113, 16
    v_readlane_b32 s66, v7, 0
    v_readlane_b32 s67, v7, 16
    v_mul_f32 v6, v6, v113
    v_mul_f32 v110, v110, v113
    v_mul_f32 v110, v110, v113
    v_mov_b32 v106, s66
    v_mov_b32 v107, s67
    v_fma_f32 v86, v70, s68, v106
    v_fma_f32 v87, v71, s69, v107
    v_fma_f32 v88, v72, s68, v106
    v_fma_f32 v89, v73, s69, v107
    v_fma_f32 v90, v74, s68, v106
    v_fma_f32 v91, v75, s69, v107
    v_fma_f32 v92, v76, s68, v106
    v_fma_f32 v93, v77, s69, v107
    v_fma_f32 v94, v78, s68, v106
    v_fma_f32 v95, v79, s69, v107
    v_fma_f32 v96, v80, s68, v106
    v_fma_f32 v97, v81, s69, v107
    v_fma_f32 v98, v82, s68, v106
    v_fma_f32 v99, v83, s69, v107
    v_fma_f32 v100, v84, s68, v106
    v_fma_f32 v101, v85, s69, v107
    v_cvt_pk_f16_f32 v116, v86, v87
    v_cvt_pk_f16_f32 v117, v88, v89
    v_cvt_pk_f16_f32 v118, v90, v91
    v_cvt_pk_f16_f32 v119, v92, v93
    v_cvt_pk_f16_f32 v120, v94, v95
    v_cvt_pk_f16_f32 v121, v96, v97
    v_cvt_pk_f16_f32 v122, v98, v99
    v_cvt_pk_f16_f32 v123, v100, v101
    ds_write_b128 v65, v[116:119]
    ds_write_b128 v65, v[120:123] offset:16
    v_cvt_pk_bf16_f32 v5, v6, v110
    v_lshlrev_b32 v108, 16, v5
    v_and_b32 v5, 0xffff0000, v5
    v_add_f32 v4, 0x3727c5ac, v5
    v_cvt_pk_bf16_f32 v4, v4, v4
    v_lshlrev_b32 v4, 16, v4
    v_sqrt_f32 v4, v4
    s_nop 0
    v_cvt_pk_bf16_f32 v4, v4, v4
    v_lshlrev_b32 v109, 16, v4
    v_fma_f32 v4, -v108, v114, -v112
    v_mul_f32 v5, v114, v109
    v_cvt_pk_bf16_f32 v124, v4, v4
    v_cvt_pk_bf16_f32 v6, v5, v5
    v_and_b32 v7, 0xffff0000, v124
    v_sub_f32 v4, v4, v7
    v_and_b32 v7, 0xffff0000, v6
    v_sub_f32 v6, v5, v7
    v_cvt_pk_bf16_f32 v125, v4, v5
    v_cvt_pk_bf16_f32 v126, v6, 0
    v_mov_b32 v127, s50
    v_lshlrev_b32 v4, 4, v12
    s_lshl_b32 s60, s61, 4
    s_add_u32 s60, s60, 196608
    s_mov_b64 exec, 0x10001
    buffer_store_dwordx4 v[124:127], v4, s[4:7], s60 offen sc1
    s_mov_b64 exec, -1
    s_waitcnt lgkmcnt(0)
    s_barrier
    ds_read2st64_b32 v[70:71], v64 offset0:0 offset1:8
    ds_read2st64_b32 v[72:73], v64 offset0:16 offset1:24
    ds_read2st64_b32 v[74:75], v64 offset0:4 offset1:12
    ds_read2st64_b32 v[76:77], v64 offset0:20 offset1:28
    s_lshl_b32 s60, s53, 13
    s_add_u32 s60, s60, 1048576
    s_add_u32 s62, s60, 4096
    s_waitcnt lgkmcnt(2)
    buffer_store_dwordx4 v[70:73], v14, s[4:7], s60 offen sc1
    s_waitcnt lgkmcnt(0)
    buffer_store_dwordx4 v[74:77], v14, s[4:7], s62 offen sc1
    s_waitcnt vmcnt(3)
    s_mov_b32 s12, s40
    s_mov_b32 s13, s41
    s_mov_b32 s14, 1835008
    s_mov_b32 s15, 0x20000
    s_mul_i32 s60, s2, 7168
    s_lshl_b32 s62, s3, 11
    s_add_u32 s60, s60, s62
    buffer_load_dwordx4 v[240:243], v8, s[12:15], s60 offen
    buffer_load_dwordx4 v[244:247], v8, s[12:15], s60 offen offset:1024
    v_lshlrev_b32 v18, 16, v9
    v_mul_f32 v18, 0x3fb8aa3b, v18
    v_exp_f32 v18, v18
    v_lshlrev_b32 v10, 16, v10
    v_lshlrev_b32 v26, 16, v26
    v_lshlrev_b32 v27, 16, v27
    v_lshlrev_b32 v28, 16, v28
    v_lshlrev_b32 v29, 16, v29
    v_lshlrev_b32 v30, 16, v30
    v_lshlrev_b32 v31, 16, v31
    v_lshlrev_b32 v32, 16, v32
    v_lshlrev_b32 v33, 16, v33
    v_lshlrev_b32 v34, 16, v34
    v_lshlrev_b32 v35, 16, v35
    v_cvt_pk_bf16_f32 v18, v18, v18
    v_lshlrev_b32 v18, 16, v18
    v_mul_f32 v21, v30, v28
    v_mul_f32 v22, v30, v29
    v_mul_f32 v4, v34, v32
    v_mul_f32 v5, v34, v33
    v_fma_f32 v21, -v31, v29, v21
    v_fma_f32 v22, v31, v28, v22
    v_fma_f32 v4, -v35, v33, v4
    v_fma_f32 v5, v35, v32, v5
    v_mul_f32 v19, v18, v26
    v_mul_f32 v20, v18, v27
    v_max_f32 v4, |v4|, |v5|
    v_max3_f32 v4, |v21|, |v22|, v4
    v_mul_f32 v19, 0x3fb8aa3b, v19
    v_mul_f32 v20, 0x3e22f983, v20
    v_max_f32_dpp v4, v4, v4 quad_perm:[1,0,3,2] row_mask:0xf bank_mask:0xf
    v_mul_f32 v92, 0x41000000, v19
    v_mul_f32 v93, 0x41000000, v20
    v_max_f32_dpp v4, v4, v4 quad_perm:[2,3,0,1] row_mask:0xf bank_mask:0xf
    v_mul_f32 v94, 0x42800000, v19
    v_mul_f32 v95, 0x42800000, v20
    v_max_f32_dpp v4, v4, v4 row_half_mirror row_mask:0xf bank_mask:0xf
    v_mul_f32 v96, 0x3f800000, v19
    v_mul_f32 v97, 0x3f800000, v20
    v_max_f32_dpp v4, v4, v4 row_mirror row_mask:0xf bank_mask:0xf
    v_mul_f32 v98, 0x43800000, v19
    v_mul_f32 v99, 0x43800000, v20
    v_max_f32_dpp v4, v4, v4 row_bcast:15 row_mask:0xa bank_mask:0xf
    v_fract_f32 v93, v93
    v_fract_f32 v95, v95
    v_fract_f32 v97, v97
    v_fract_f32 v99, v99
    v_max_f32_dpp v4, v4, v4 row_bcast:31 row_mask:0xc bank_mask:0xf
    v_exp_f32 v92, v92
    v_cos_f32 v86, v93
    v_sin_f32 v87, v93
    v_frexp_exp_i32_f32 v4, v4
    v_exp_f32 v94, v94
    v_cos_f32 v88, v95
    v_sin_f32 v89, v95
    v_readlane_b32 s72, v4, 63
    s_nop 0
    s_sub_u32 s73, 0, s72
    v_exp_f32 v96, v96
    v_cos_f32 v23, v97
    v_sin_f32 v24, v97
    v_exp_f32 v98, v98
    v_cos_f32 v90, v99
    v_sin_f32 v91, v99
    v_mul_f32 v86, v86, v92
    v_mul_f32 v87, v87, v92
    v_mul_f32 v88, v88, v94
    v_mul_f32 v89, v89, v94
    v_mul_f32 v23, v23, v96
    v_mul_f32 v24, v24, v96
    v_mul_f32 v90, v90, v98
    v_mul_f32 v91, v91, v98
    v_ldexp_f32 v21, v21, s73
    v_ldexp_f32 v22, v22, s73
    v_ldexp_f32 v18, v18, s72
    v_cvt_pk_f16_f32 v92, v86, v87
    v_cvt_pk_f16_f32 v93, v88, v89
    v_cvt_pk_f16_f32 v94, v21, -v22
    v_mul_f32 v25, v86, v86
    v_mul_f32 v26, v86, v87
    v_mul_f32 v146, v88, v88
    v_mul_f32 v147, v88, v89
    v_mul_f32 v150, v21, v23
    v_mul_f32 v151, v21, v24
    v_mul_f32 v164, v21, v90
    v_mul_f32 v165, v21, v91
    v_fma_f32 v25, -v87, v87, v25
    v_fma_f32 v26, v87, v86, v26
    v_fma_f32 v146, -v89, v89, v146
    v_fma_f32 v147, v89, v88, v147
    v_fma_f32 v150, -v22, v24, v150
    v_fma_f32 v151, v22, v23, v151
    v_fma_f32 v164, -v22, v91, v164
    v_fma_f32 v165, v22, v90, v165
    v_cvt_pk_f16_f32 v95, v25, v26
    v_cvt_pk_f16_f32 v96, v146, v147
    v_cvt_pk_f16_f32 v97, v150, -v151
    v_cvt_pk_f16_f32 v98, v164, -v165
    v_mul_f32 v27, v25, v86
    v_mul_f32 v28, v25, v87
    v_mul_f32 v29, v25, v25
    v_mul_f32 v30, v25, v26
    v_mul_f32 v148, v146, v88
    v_mul_f32 v149, v146, v89
    v_mul_f32 v152, v150, v23
    v_mul_f32 v153, v150, v24
    v_mul_f32 v166, v164, v90
    v_mul_f32 v167, v164, v91
    v_fma_f32 v27, -v26, v87, v27
    v_fma_f32 v28, v26, v86, v28
    v_fma_f32 v29, -v26, v26, v29
    v_fma_f32 v30, v26, v25, v30
    v_fma_f32 v148, -v147, v89, v148
    v_fma_f32 v149, v147, v88, v149
    v_fma_f32 v152, -v151, v24, v152
    v_fma_f32 v153, v151, v23, v153
    v_fma_f32 v166, -v165, v91, v166
    v_fma_f32 v167, v165, v90, v167
    v_cvt_pk_f16_f32 v99, v27, v28
    v_cvt_pk_f16_f32 v100, v29, v30
    v_cvt_pk_f16_f32 v101, v148, v149
    v_cvt_pk_f16_f32 v102, v152, -v153
    v_cvt_pk_f16_f32 v103, v166, -v167
    v_mul_f32 v31, v29, v86
    v_mul_f32 v32, v29, v87
    v_mul_f32 v33, v29, v25
    v_mul_f32 v34, v29, v26
    v_mul_f32 v144, v29, v27
    v_mul_f32 v145, v29, v28
    v_mul_f32 v154, v152, v23
    v_mul_f32 v155, v152, v24
    v_mul_f32 v164, v166, v90
    v_mul_f32 v165, v166, v91
    v_fma_f32 v31, -v30, v87, v31
    v_fma_f32 v32, v30, v86, v32
    v_fma_f32 v33, -v30, v26, v33
    v_fma_f32 v34, v30, v25, v34
    v_fma_f32 v144, -v30, v28, v144
    v_fma_f32 v145, v30, v27, v145
    v_fma_f32 v154, -v153, v24, v154
    v_fma_f32 v155, v153, v23, v155
    v_fma_f32 v164, -v167, v91, v164
    v_fma_f32 v165, v167, v90, v165
    v_cvt_pk_f16_f32 v104, v31, v32
    v_cvt_pk_f16_f32 v105, v33, v34
    v_cvt_pk_f16_f32 v106, v144, v145
    v_cvt_pk_f16_f32 v107, v154, -v155
    v_cvt_pk_f16_f32 v108, v164, -v165
    s_waitcnt vmcnt(2)
    v_mov_b32 v6, s50
    v_mov_b32 v7, s51
    s_lshl_b32 s60, s3, 8
    s_add_u32 s60, s60, s53
    s_lshl_b32 s60, s60, 6
    s_add_u32 s60, s60, 393216
    v_mov_b32 v5, 0
    s_mov_b64 exec, 1
    buffer_store_dwordx2 v[6:7], v5, s[4:7], s60 offen sc1
    s_mov_b64 exec, -1
    v_mul_f32 v156, v154, v23
    v_mul_f32 v157, v154, v24
    v_mul_f32 v166, v164, v90
    v_mul_f32 v167, v164, v91
    v_mul_f32 v172, v152, v90
    v_mul_f32 v173, v152, v91
    v_mul_f32 v174, v86, v88
    v_mul_f32 v175, v86, v89
    v_mul_f32 v176, v25, v88
    v_mul_f32 v177, v25, v89
    v_fma_f32 v156, -v155, v24, v156
    v_fma_f32 v157, v155, v23, v157
    v_fma_f32 v166, -v165, v91, v166
    v_fma_f32 v167, v165, v90, v167
    v_fma_f32 v172, -v153, v91, v172
    v_fma_f32 v173, v153, v90, v173
    v_fma_f32 v174, -v87, v89, v174
    v_fma_f32 v175, v87, v88, v175
    v_fma_f32 v176, -v26, v89, v176
    v_fma_f32 v177, v26, v88, v177
    v_cvt_pk_f16_f32 v109, v156, -v157
    v_cvt_pk_f16_f32 v110, v166, -v167
    v_cvt_pk_f16_f32 v111, v172, -v173
    v_cvt_pk_f16_f32 v112, v174, v175
    v_cvt_pk_f16_f32 v113, v176, v177
    v_mul_f32 v158, v156, v23
    v_mul_f32 v159, v156, v24
    v_mul_f32 v164, v166, v90
    v_mul_f32 v165, v166, v91
    v_mul_f32 v168, v156, v90
    v_mul_f32 v169, v156, v91
    v_mul_f32 v172, v27, v88
    v_mul_f32 v173, v27, v89
    v_mul_f32 v174, v29, v88
    v_mul_f32 v175, v29, v89
    v_fma_f32 v158, -v157, v24, v158
    v_fma_f32 v159, v157, v23, v159
    v_fma_f32 v164, -v167, v91, v164
    v_fma_f32 v165, v167, v90, v165
    v_fma_f32 v168, -v157, v91, v168
    v_fma_f32 v169, v157, v90, v169
    v_fma_f32 v172, -v28, v89, v172
    v_fma_f32 v173, v28, v88, v173
    v_fma_f32 v174, -v30, v89, v174
    v_fma_f32 v175, v30, v88, v175
    v_cvt_pk_f16_f32 v114, v158, -v159
    v_cvt_pk_f16_f32 v115, v164, -v165
    v_cvt_pk_f16_f32 v116, v168, -v169
    v_cvt_pk_f16_f32 v117, v172, v173
    v_cvt_pk_f16_f32 v118, v174, v175
    v_mul_f32 v160, v158, v23
    v_mul_f32 v161, v158, v24
    v_mul_f32 v166, v164, v90
    v_mul_f32 v167, v164, v91
    v_mul_f32 v170, v168, v90
    v_mul_f32 v171, v168, v91
    v_mul_f32 v172, v31, v88
    v_mul_f32 v173, v31, v89
    v_mul_f32 v174, v33, v88
    v_mul_f32 v175, v33, v89
    v_fma_f32 v160, -v159, v24, v160
    v_fma_f32 v161, v159, v23, v161
    v_fma_f32 v166, -v165, v91, v166
    v_fma_f32 v167, v165, v90, v167
    v_fma_f32 v170, -v169, v91, v170
    v_fma_f32 v171, v169, v90, v171
    v_fma_f32 v172, -v32, v89, v172
    v_fma_f32 v173, v32, v88, v173
    v_fma_f32 v174, -v34, v89, v174
    v_fma_f32 v175, v34, v88, v175
    v_cvt_pk_f16_f32 v119, v160, -v161
    v_cvt_pk_f16_f32 v120, v166, -v167
    v_cvt_pk_f16_f32 v121, v170, -v171
    v_cvt_pk_f16_f32 v122, v172, v173
    v_cvt_pk_f16_f32 v123, v174, v175
    v_mul_f32 v162, v160, v23
    v_mul_f32 v163, v160, v24
    v_mul_f32 v164, v166, v90
    v_mul_f32 v165, v166, v91
    v_mul_f32 v168, v170, v90
    v_mul_f32 v169, v170, v91
    v_mul_f32 v172, v160, v90
    v_mul_f32 v173, v160, v91
    v_mul_f32 v174, v144, v88
    v_mul_f32 v175, v144, v89
    v_fma_f32 v162, -v161, v24, v162
    v_fma_f32 v163, v161, v23, v163
    v_fma_f32 v164, -v167, v91, v164
    v_fma_f32 v165, v167, v90, v165
    v_fma_f32 v168, -v171, v91, v168
    v_fma_f32 v169, v171, v90, v169
    v_fma_f32 v172, -v161, v91, v172
    v_fma_f32 v173, v161, v90, v173
    v_fma_f32 v174, -v145, v89, v174
    v_fma_f32 v175, v145, v88, v175
    v_cvt_pk_f16_f32 v124, v162, -v163
    v_cvt_pk_f16_f32 v125, v164, -v165
    v_cvt_pk_f16_f32 v126, v168, -v169
    v_cvt_pk_f16_f32 v127, v172, -v173
    v_cvt_pk_f16_f32 v128, v174, v175
    v_mul_f32 v166, v164, v90
    v_mul_f32 v167, v164, v91
    v_mul_f32 v172, v86, v146
    v_mul_f32 v173, v86, v147
    v_mul_f32 v174, v25, v146
    v_mul_f32 v175, v25, v147
    v_mul_f32 v176, v27, v146
    v_mul_f32 v177, v27, v147
    v_mul_f32 v178, v29, v146
    v_mul_f32 v179, v29, v147
    v_fma_f32 v166, -v165, v91, v166
    v_fma_f32 v167, v165, v90, v167
    v_fma_f32 v172, -v87, v147, v172
    v_fma_f32 v173, v87, v146, v173
    v_fma_f32 v174, -v26, v147, v174
    v_fma_f32 v175, v26, v146, v175
    v_fma_f32 v176, -v28, v147, v176
    v_fma_f32 v177, v28, v146, v177
    v_fma_f32 v178, -v30, v147, v178
    v_fma_f32 v179, v30, v146, v179
    v_cvt_pk_f16_f32 v129, v166, -v167
    v_cvt_pk_f16_f32 v130, v172, v173
    v_cvt_pk_f16_f32 v131, v174, v175
    v_cvt_pk_f16_f32 v132, v176, v177
    v_cvt_pk_f16_f32 v133, v178, v179
    v_mul_f32 v172, v31, v146
    v_mul_f32 v173, v31, v147
    v_mul_f32 v174, v33, v146
    v_mul_f32 v175, v33, v147
    v_mul_f32 v176, v144, v146
    v_mul_f32 v177, v144, v147
    v_mul_f32 v178, v86, v148
    v_mul_f32 v179, v86, v149
    v_fma_f32 v172, -v32, v147, v172
    v_fma_f32 v173, v32, v146, v173
    v_fma_f32 v174, -v34, v147, v174
    v_fma_f32 v175, v34, v146, v175
    v_fma_f32 v176, -v145, v147, v176
    v_fma_f32 v177, v145, v146, v177
    v_fma_f32 v178, -v87, v149, v178
    v_fma_f32 v179, v87, v148, v179
    v_cvt_pk_f16_f32 v134, v172, v173
    v_cvt_pk_f16_f32 v135, v174, v175
    v_cvt_pk_f16_f32 v136, v176, v177
    v_cvt_pk_f16_f32 v137, v178, v179
    v_mul_f32 v172, v25, v148
    v_mul_f32 v173, v25, v149
    v_mul_f32 v174, v27, v148
    v_mul_f32 v175, v27, v149
    v_mul_f32 v176, v29, v148
    v_mul_f32 v177, v29, v149
    v_mul_f32 v178, v31, v148
    v_mul_f32 v179, v31, v149
    v_fma_f32 v172, -v26, v149, v172
    v_fma_f32 v173, v26, v148, v173
    v_fma_f32 v174, -v28, v149, v174
    v_fma_f32 v175, v28, v148, v175
    v_fma_f32 v176, -v30, v149, v176
    v_fma_f32 v177, v30, v148, v177
    v_fma_f32 v178, -v32, v149, v178
    v_fma_f32 v179, v32, v148, v179
    v_cvt_pk_f16_f32 v138, v172, v173
    v_cvt_pk_f16_f32 v139, v174, v175
    v_cvt_pk_f16_f32 v140, v176, v177
    v_cvt_pk_f16_f32 v141, v178, v179
    v_mul_f32 v172, v33, v148
    v_mul_f32 v173, v33, v149
    v_mul_f32 v174, v144, v148
    v_mul_f32 v175, v144, v149
    v_fma_f32 v172, -v34, v149, v172
    v_fma_f32 v173, v34, v148, v173
    v_fma_f32 v174, -v145, v149, v174
    v_fma_f32 v175, v145, v148, v175
    v_cvt_pk_f16_f32 v142, v172, v173
    v_cvt_pk_f16_f32 v143, v174, v175
    v_lshlrev_b32 v7, 3, v0
    v_add_u32 v39, 7, v7
    v_max_i32 v4, 128, v39
    v_cvt_f32_i32 v4, v4
    v_add_u32 v40, 6, v7
    v_max_i32 v5, 128, v40
    v_cvt_f32_i32 v5, v5
    v_cvt_pk_bf16_f32 v4, v4, v5
    v_lshrrev_b32 v5, 16, v4
    v_and_b32 v4, 0xffff, v4
    v_subrev_u32 v4, 0x4280, v4
    v_min_i32 v39, v4, v39
    v_lshlrev_b32 v39, 1, v39
    v_subrev_u32 v5, 0x4280, v5
    v_min_i32 v40, v5, v40
    v_lshlrev_b32 v40, 1, v40
    v_add_u32 v41, 5, v7
    v_max_i32 v4, 128, v41
    v_cvt_f32_i32 v4, v4
    v_add_u32 v42, 4, v7
    v_max_i32 v5, 128, v42
    v_cvt_f32_i32 v5, v5
    v_cvt_pk_bf16_f32 v4, v4, v5
    v_lshrrev_b32 v5, 16, v4
    v_and_b32 v4, 0xffff, v4
    v_subrev_u32 v4, 0x4280, v4
    v_min_i32 v41, v4, v41
    v_lshlrev_b32 v41, 1, v41
    v_subrev_u32 v5, 0x4280, v5
    v_min_i32 v42, v5, v42
    v_lshlrev_b32 v42, 1, v42
    v_add_u32 v43, 3, v7
    v_max_i32 v4, 128, v43
    v_cvt_f32_i32 v4, v4
    v_add_u32 v44, 2, v7
    v_max_i32 v5, 128, v44
    v_cvt_f32_i32 v5, v5
    v_cvt_pk_bf16_f32 v4, v4, v5
    v_lshrrev_b32 v5, 16, v4
    v_and_b32 v4, 0xffff, v4
    v_subrev_u32 v4, 0x4280, v4
    v_min_i32 v43, v4, v43
    v_lshlrev_b32 v43, 1, v43
    v_subrev_u32 v5, 0x4280, v5
    v_min_i32 v44, v5, v44
    v_lshlrev_b32 v44, 1, v44
    v_add_u32 v45, 1, v7
    v_max_i32 v4, 128, v45
    v_cvt_f32_i32 v4, v4
    v_add_u32 v46, 0, v7
    v_max_i32 v5, 128, v46
    v_cvt_f32_i32 v5, v5
    v_cvt_pk_bf16_f32 v4, v4, v5
    v_lshrrev_b32 v5, 16, v4
    v_and_b32 v4, 0xffff, v4
    v_subrev_u32 v4, 0x4280, v4
    v_min_i32 v45, v4, v45
    v_lshlrev_b32 v45, 1, v45
    v_subrev_u32 v5, 0x4280, v5
    v_min_i32 v46, v5, v46
    v_lshlrev_b32 v46, 1, v46
    v_add_u32 v47, -1, v7
    v_max_i32 v4, 128, v47
    v_cvt_f32_i32 v4, v4
    v_add_u32 v48, -2, v7
    v_max_i32 v5, 128, v48
    v_cvt_f32_i32 v5, v5
    v_cvt_pk_bf16_f32 v4, v4, v5
    v_lshrrev_b32 v5, 16, v4
    v_and_b32 v4, 0xffff, v4
    v_subrev_u32 v4, 0x4280, v4
    v_min_i32 v47, v4, v47
    v_lshlrev_b32 v47, 1, v47
    v_subrev_u32 v5, 0x4280, v5
    v_min_i32 v48, v5, v48
    v_lshlrev_b32 v48, 1, v48
    v_add_u32 v49, -3, v7
    v_max_i32 v4, 128, v49
    v_cvt_f32_i32 v4, v4
    v_add_u32 v50, -4, v7
    v_max_i32 v5, 128, v50
    v_cvt_f32_i32 v5, v5
    v_cvt_pk_bf16_f32 v4, v4, v5
    v_lshrrev_b32 v5, 16, v4
    v_and_b32 v4, 0xffff, v4
    v_subrev_u32 v4, 0x4280, v4
    v_min_i32 v49, v4, v49
    v_lshlrev_b32 v49, 1, v49
    v_subrev_u32 v5, 0x4280, v5
    v_min_i32 v50, v5, v50
    v_lshlrev_b32 v50, 1, v50
    v_add_u32 v51, -5, v7
    v_max_i32 v4, 128, v51
    v_cvt_f32_i32 v4, v4
    v_add_u32 v52, -6, v7
    v_max_i32 v5, 128, v52
    v_cvt_f32_i32 v5, v5
    v_cvt_pk_bf16_f32 v4, v4, v5
    v_lshrrev_b32 v5, 16, v4
    v_and_b32 v4, 0xffff, v4
    v_subrev_u32 v4, 0x4280, v4
    v_min_i32 v51, v4, v51
    v_lshlrev_b32 v51, 1, v51
    v_subrev_u32 v5, 0x4280, v5
    v_min_i32 v52, v5, v52
    v_lshlrev_b32 v52, 1, v52
    v_add_u32 v53, -7, v7
    v_max_i32 v4, 128, v53
    v_cvt_f32_i32 v4, v4
    v_cvt_pk_bf16_f32 v4, v4, v5
    v_lshrrev_b32 v5, 16, v4
    v_and_b32 v4, 0xffff, v4
    v_subrev_u32 v4, 0x4280, v4
    v_min_i32 v53, v4, v53
    v_lshlrev_b32 v53, 1, v53
    s_lshl_b32 s60, s58, 4
    v_add_u32 v7, s60, v11
    s_mul_i32 s60, s57, 1344
    v_lshlrev_b32 v4, 4, v7
    v_lshl_add_u32 v54, v12, 3, v4
    v_lshlrev_b32 v4, 3, v7
    v_add_u32 v4, 512, v4
    v_cmp_eq_u32 vcc, 2, v12
    s_nop 1
    v_cndmask_b32 v54, v54, v4, vcc
    v_lshlrev_b32 v4, 2, v7
    v_add_u32 v4, 768, v4
    v_cmp_eq_u32 vcc, 3, v12
    s_nop 1
    v_cndmask_b32 v54, v54, v4, vcc
    v_add_u32 v54, s60, v54
    v_mov_b32 v5, 128
    v_cndmask_b32 v5, 4, v5, vcc
    v_add_u32 v55, v54, v5
    v_lshlrev_b32 v4, 1, v7
    v_add_u32 v4, 1024, v4
    v_mov_b32 v5, 1104
    v_cmp_eq_u32 vcc, 0, v12
    s_nop 1
    v_cndmask_b32 v57, v5, v4, vcc
    v_mov_b32 v5, 1296
    v_cndmask_b32 v56, v5, v4, vcc
    v_lshl_add_u32 v4, v7, 2, v12
    v_mov_b32 v5, 1280
    v_cmp_eq_u32 vcc, 1, v4
    s_nop 1
    v_cndmask_b32 v56, v56, v5, vcc
    v_add_u32 v56, s60, v56
    v_add_u32 v57, s60, v57
    s_mul_i32 s60, s57, 28032
    s_lshl_b32 s62, s58, 8
    s_add_u32 s62, s62, s60
    v_lshl_add_u32 v58, v1, 2, s62
    v_mul_u32_u24 v4, 528, v11
    v_lshl_add_u32 v4, v12, 4, v4
    v_add_u32 v60, s60, v4
    s_mul_i32 s62, s58, 8448
    v_add_u32 v59, s62, v60
    v_add_u32 v15, 33280, v14
    v_lshrrev_b32 v13, 1, v1
    v_lshlrev_b32 v61, 4, v13
    v_lshlrev_b32 v13, 13, v13
    v_and_b32 v4, 1, v1
    v_lshl_add_u32 v13, v4, 4, v13
    v_mul_u32_u24 v5, 4608, v4
    s_lshl_b32 s60, s3, 10
    v_add3_u32 v61, v61, v5, s60
    s_lshl_b32 s74, s3, 19
    s_lshl_b32 s60, s59, 5
    s_add_u32 s74, s74, s60
    s_add_u32 s74, s74, 1048576
    s_lshr_b32 s55, s59, 5
    s_and_b32 s55, s55, 3
    s_lshl_b32 s55, s55, 14
    s_add_u32 s55, s55, 393216
    v_lshlrev_b32 v64, 6, v0
    s_lshl_b32 s62, s58, 8
    v_and_b32 v16, 7, v11
    v_mul_u32_u24 v16, 4160, v16
    v_lshrrev_b32 v4, 3, v11
    v_sub_u32 v4, v4, v12
    v_add_u32 v4, 3, v4
    v_lshl_add_u32 v16, v4, 4, v16
    s_mul_i32 s75, s57, 33280
    s_add_u32 s75, s75, s62
    v_add_u32 v16, s75, v16
    v_lshlrev_b32 v17, 5, v11
    v_lshl_add_u32 v62, v12, 3, v17
    v_lshl_add_u32 v17, v12, 4, v17
    s_mul_i32 s75, s57, 4608
    s_lshl_b32 s60, s58, 11
    s_add_u32 s60, s60, s75
    v_add_u32 v62, s60, v62
    s_sub_u32 s75, s75, s62
    s_add_u32 s75, s75, 288
    v_add_u32 v17, s75, v17
    v_lshlrev_b32 v63, 5, v11
    v_lshrrev_b32 v4, 1, v12
    v_lshl_add_u32 v63, v4, 4, v63
    v_and_b32 v4, 1, v12
    v_lshl_add_u32 v63, v4, 9, v63
    s_lshl_b32 s56, s63, 12
    s_lshl_b32 s60, s58, 11
    s_add_u32 s56, s56, s60
    s_add_u32 s56, s56, 3145728
    v_mov_b32 v66, 0
    v_mov_b32 v67, 0
    v_mov_b32 v68, 0
    v_mov_b32 v69, 0
    s_mul_i32 s75, s57, 4608
    v_lshl_add_u32 v4, v1, 3, s75
    ds_write_b64 v4, v[66:67] offset:0
    s_mul_i32 s75, s57, 1344
    v_mov_b32 v4, s75
    ds_write_b128 v4, v[66:69] offset:9216
    v_mov_b32 v4, 0x3c00
    ds_write_b32 v58, v4 offset:12288
    ds_write_b32 v58, v92 offset:12816
    ds_write_b32 v58, v93 offset:16512
    ds_write_b32 v58, v94 offset:29184
    ds_write_b32 v58, v95 offset:13344
    ds_write_b32 v58, v96 offset:20736
    ds_write_b32 v58, v97 offset:29712
    ds_write_b32 v58, v98 offset:33408
    ds_write_b32 v58, v99 offset:13872
    ds_write_b32 v58, v100 offset:14400
    ds_write_b32 v58, v101 offset:24960
    ds_write_b32 v58, v102 offset:30240
    ds_write_b32 v58, v103 offset:35520
    ds_write_b32 v58, v104 offset:14928
    ds_write_b32 v58, v105 offset:15456
    ds_write_b32 v58, v106 offset:15984
    ds_write_b32 v58, v107 offset:30768
    ds_write_b32 v58, v108 offset:36576
    ds_write_b32 v58, v109 offset:31296
    ds_write_b32 v58, v110 offset:37632
    ds_write_b32 v58, v111 offset:33936
    ds_write_b32 v58, v112 offset:17040
    ds_write_b32 v58, v113 offset:17568
    ds_write_b32 v58, v114 offset:31824
    ds_write_b32 v58, v115 offset:38160
    ds_write_b32 v58, v116 offset:34464
    ds_write_b32 v58, v117 offset:18096
    ds_write_b32 v58, v118 offset:18624
    ds_write_b32 v58, v119 offset:32352
    ds_write_b32 v58, v120 offset:38688
    ds_write_b32 v58, v121 offset:36048
    ds_write_b32 v58, v122 offset:19152
    ds_write_b32 v58, v123 offset:19680
    ds_write_b32 v58, v124 offset:32880
    ds_write_b32 v58, v125 offset:39216
    ds_write_b32 v58, v126 offset:37104
    ds_write_b32 v58, v127 offset:34992
    ds_write_b32 v58, v128 offset:20208
    ds_write_b32 v58, v129 offset:39744
    ds_write_b32 v58, v130 offset:21264
    ds_write_b32 v58, v131 offset:21792
    ds_write_b32 v58, v132 offset:22320
    ds_write_b32 v58, v133 offset:22848
    ds_write_b32 v58, v134 offset:23376
    ds_write_b32 v58, v135 offset:23904
    ds_write_b32 v58, v136 offset:24432
    ds_write_b32 v58, v137 offset:25488
    ds_write_b32 v58, v138 offset:26016
    ds_write_b32 v58, v139 offset:26544
    ds_write_b32 v58, v140 offset:27072
    ds_write_b32 v58, v141 offset:27600
    ds_write_b32 v58, v142 offset:28128
    ds_write_b32 v58, v143 offset:28656
    buffer_load_dwordx2 v[28:29], v64, s[4:7], s55 offen sc1
    s_waitcnt lgkmcnt(0)
    s_barrier
    ds_read_b128 v[80:83], v59 offset:12288
    ds_read_b128 v[84:87], v60 offset:29184
    ds_read_b128 v[88:91], v60 offset:37632
    ds_read_b128 v[92:95], v59 offset:12352
    ds_read_b128 v[96:99], v60 offset:29248
    ds_read_b128 v[100:103], v60 offset:37696
    ds_read_b128 v[104:107], v59 offset:12416
    ds_read_b128 v[108:111], v60 offset:29312
    ds_read_b128 v[112:115], v60 offset:37760
    ds_read_b128 v[116:119], v59 offset:12480
    ds_read_b128 v[120:123], v60 offset:29376
    ds_read_b128 v[124:127], v60 offset:37824
    s_waitcnt lgkmcnt(9)
    v_mfma_f32_16x16x32_f16 v[72:75], v[84:87], v[80:83], 0
    v_mfma_f32_16x16x32_f16 v[76:79], v[88:91], v[80:83], 0
    ds_read_b128 v[128:131], v59 offset:12544
    ds_read_b128 v[132:135], v60 offset:29440
    ds_read_b128 v[136:139], v60 offset:37888
    s_waitcnt lgkmcnt(9)
    v_mfma_f32_16x16x32_f16 v[72:75], v[96:99], v[92:95], v[72:75]
    v_mfma_f32_16x16x32_f16 v[76:79], v[100:103], v[92:95], v[76:79]
    ds_read_b128 v[140:143], v59 offset:12608
    ds_read_b128 v[144:147], v60 offset:29504
    ds_read_b128 v[148:151], v60 offset:37952
    s_waitcnt lgkmcnt(9)
    v_mfma_f32_16x16x32_f16 v[72:75], v[108:111], v[104:107], v[72:75]
    v_mfma_f32_16x16x32_f16 v[76:79], v[112:115], v[104:107], v[76:79]
    ds_read_b128 v[152:155], v59 offset:12672
    ds_read_b128 v[156:159], v60 offset:29568
    ds_read_b128 v[160:163], v60 offset:38016
    s_waitcnt lgkmcnt(9)
    v_mfma_f32_16x16x32_f16 v[72:75], v[120:123], v[116:119], v[72:75]
    v_mfma_f32_16x16x32_f16 v[76:79], v[124:127], v[116:119], v[76:79]
    ds_read_b128 v[164:167], v59 offset:12736
    ds_read_b128 v[168:171], v60 offset:29632
    ds_read_b128 v[172:175], v60 offset:38080
    s_waitcnt lgkmcnt(9)
    v_mfma_f32_16x16x32_f16 v[72:75], v[132:135], v[128:131], v[72:75]
    v_mfma_f32_16x16x32_f16 v[76:79], v[136:139], v[128:131], v[76:79]
    s_waitcnt lgkmcnt(6)
    v_mfma_f32_16x16x32_f16 v[72:75], v[144:147], v[140:143], v[72:75]
    v_mfma_f32_16x16x32_f16 v[76:79], v[148:151], v[140:143], v[76:79]
    s_waitcnt lgkmcnt(3)
    v_mfma_f32_16x16x32_f16 v[72:75], v[156:159], v[152:155], v[72:75]
    v_mfma_f32_16x16x32_f16 v[76:79], v[160:163], v[152:155], v[76:79]
    s_waitcnt lgkmcnt(0)
    v_mfma_f32_16x16x32_f16 v[72:75], v[168:171], v[164:167], v[72:75]
    v_mfma_f32_16x16x32_f16 v[76:79], v[172:175], v[164:167], v[76:79]
    s_nop 6
    v_cvt_pk_f16_f32 v80, v72, v73
    v_cvt_pk_f16_f32 v81, v74, v75
    v_cvt_pk_f16_f32 v82, v76, v77
    v_cvt_pk_f16_f32 v83, v78, v79
    ds_write_b32 v54, v80 offset:9232
    ds_write_b32 v55, v81 offset:9232
    ds_write_b16 v56, v82 offset:9232
    s_mov_b64 exec, 0xffff
    ds_write_b16_d16_hi v57, v82 offset:9296
    ds_write_b16 v57, v83 offset:9360
    ds_write_b16_d16_hi v57, v83 offset:9424
    s_mov_b64 exec, -1
    s_waitcnt lgkmcnt(0)
    s_barrier
    s_mov_b32 s62, 0
L_b_poll:
    s_waitcnt vmcnt(0)
    v_xor_b32 v4, s50, v28
    v_xor_b32 v5, s51, v29
    v_or_b32 v4, v4, v5
    v_cmp_ne_u32 vcc, 0, v4
    s_add_u32 s62, s62, 1
    s_cmp_eq_u64 vcc, 0
    s_cbranch_scc1 L_b_got
    s_cmp_ge_u32 s62, 200000
    s_cbranch_scc1 L_b_got
    s_sleep 1
    buffer_load_dwordx2 v[28:29], v64, s[4:7], s55 offen sc1
    s_branch L_b_poll
L_b_got:
    s_add_u32 s60, s74, 262144
    buffer_load_dwordx4 v[20:23], v13, s[4:7], s74 offen sc1
    buffer_load_dwordx4 v[24:27], v13, s[4:7], s60 offen sc1
    ds_read_u16 v141, v39 offset:9232
    ds_read_u16 v142, v40 offset:9232
    ds_read_u16 v143, v41 offset:9232
    ds_read_u16 v144, v42 offset:9232
    ds_read_u16 v145, v43 offset:9232
    ds_read_u16 v146, v44 offset:9232
    ds_read_u16 v147, v45 offset:9232
    ds_read_u16 v148, v46 offset:9232
    ds_read_u16 v149, v47 offset:9232
    ds_read_u16 v150, v48 offset:9232
    ds_read_u16 v151, v49 offset:9232
    ds_read_u16 v152, v50 offset:9232
    ds_read_u16 v153, v51 offset:9232
    ds_read_u16 v154, v52 offset:9232
    ds_read_u16 v155, v53 offset:9232
    ds_read_u16 v156, v39 offset:10576
    ds_read_u16 v157, v40 offset:10576
    ds_read_u16 v158, v41 offset:10576
    ds_read_u16 v159, v42 offset:10576
    ds_read_u16 v160, v43 offset:10576
    ds_read_u16 v161, v44 offset:10576
    ds_read_u16 v162, v45 offset:10576
    ds_read_u16 v163, v46 offset:10576
    ds_read_u16 v164, v47 offset:10576
    ds_read_u16 v165, v48 offset:10576
    ds_read_u16 v166, v49 offset:10576
    ds_read_u16 v167, v50 offset:10576
    ds_read_u16 v168, v51 offset:10576
    ds_read_u16 v169, v52 offset:10576
    ds_read_u16 v170, v53 offset:10576
    v_mul_u32_u24 v4, 4160, v11
    ds_write_b128 v4, v[66:69] offset:12288
    s_waitcnt lgkmcnt(15)
    v_lshl_or_b32 v70, v142, 16, v141
    v_lshl_or_b32 v71, v144, 16, v143
    v_lshl_or_b32 v72, v146, 16, v145
    v_lshl_or_b32 v73, v148, 16, v147
    v_lshl_or_b32 v74, v150, 16, v149
    v_lshl_or_b32 v75, v152, 16, v151
    ds_write_b128 v14, v[70:73] offset:41424
    ds_write_b128 v14, v[72:75] offset:24784
    v_lshl_or_b32 v88, v143, 16, v142
    v_lshl_or_b32 v89, v145, 16, v144
    v_lshl_or_b32 v90, v147, 16, v146
    v_lshl_or_b32 v91, v149, 16, v148
    v_lshl_or_b32 v92, v151, 16, v150
    v_lshl_or_b32 v93, v153, 16, v152
    ds_write_b128 v14, v[88:91] offset:37264
    ds_write_b128 v14, v[90:93] offset:20624
    v_lshl_or_b32 v80, v144, 16, v143
    v_lshl_or_b32 v81, v146, 16, v145
    v_lshl_or_b32 v82, v148, 16, v147
    v_lshl_or_b32 v83, v150, 16, v149
    v_lshl_or_b32 v84, v152, 16, v151
    v_lshl_or_b32 v85, v154, 16, v153
    ds_write_b128 v14, v[80:83] offset:33104
    ds_write_b128 v14, v[82:85] offset:16464
    v_lshl_or_b32 v98, v145, 16, v144
    v_lshl_or_b32 v99, v147, 16, v146
    v_lshl_or_b32 v100, v149, 16, v148
    v_lshl_or_b32 v101, v151, 16, v150
    v_lshl_or_b32 v102, v153, 16, v152
    v_lshl_or_b32 v103, v155, 16, v154
    ds_write_b128 v14, v[98:101] offset:28944
    ds_write_b128 v14, v[100:103] offset:12304
    s_waitcnt lgkmcnt(9)
    v_lshl_or_b32 v106, v157, 16, v156
    v_lshl_or_b32 v107, v159, 16, v158
    v_lshl_or_b32 v108, v161, 16, v160
    v_lshl_or_b32 v109, v163, 16, v162
    v_lshl_or_b32 v110, v165, 16, v164
    v_lshl_or_b32 v111, v167, 16, v166
    ds_write_b128 v15, v[106:109] offset:41424
    ds_write_b128 v15, v[108:111] offset:24784
    v_lshl_or_b32 v124, v158, 16, v157
    v_lshl_or_b32 v125, v160, 16, v159
    v_lshl_or_b32 v126, v162, 16, v161
    v_lshl_or_b32 v127, v164, 16, v163
    v_lshl_or_b32 v128, v166, 16, v165
    v_lshl_or_b32 v129, v168, 16, v167
    ds_write_b128 v15, v[124:127] offset:37264
    ds_write_b128 v15, v[126:129] offset:20624
    v_lshl_or_b32 v116, v159, 16, v158
    v_lshl_or_b32 v117, v161, 16, v160
    v_lshl_or_b32 v118, v163, 16, v162
    v_lshl_or_b32 v119, v165, 16, v164
    v_lshl_or_b32 v120, v167, 16, v166
    v_lshl_or_b32 v121, v169, 16, v168
    ds_write_b128 v15, v[116:119] offset:33104
    ds_write_b128 v15, v[118:121] offset:16464
    v_lshl_or_b32 v134, v160, 16, v159
    v_lshl_or_b32 v135, v162, 16, v161
    v_lshl_or_b32 v136, v164, 16, v163
    v_lshl_or_b32 v137, v166, 16, v165
    v_lshl_or_b32 v138, v168, 16, v167
    v_lshl_or_b32 v139, v170, 16, v169
    ds_write_b128 v15, v[134:137] offset:28944
    ds_write_b128 v15, v[136:139] offset:12304
    s_waitcnt vmcnt(0)
    ds_write_b128 v61, v[20:23] offset:512
    ds_write_b128 v61, v[24:27] offset:1024
    s_waitcnt lgkmcnt(0)
    s_barrier
    ds_read_b128 v[104:107], v16 offset:12288
    ds_read_b128 v[168:171], v17 offset:192
    ds_read_b128 v[108:111], v16 offset:12800
    ds_read_b128 v[172:175], v17 offset:704
    ds_read_b128 v[112:115], v16 offset:13312
    ds_read_b128 v[176:179], v17 offset:1216
    ds_read_b128 v[116:119], v16 offset:13824
    ds_read_b128 v[180:183], v17 offset:1728
    s_waitcnt lgkmcnt(6)
    v_mfma_f32_16x16x32_f16 v[72:75], v[104:107], v[168:171], 0
    ds_read_b128 v[120:123], v16 offset:14336
    s_waitcnt lgkmcnt(5)
    v_mfma_f32_16x16x32_f16 v[76:79], v[104:107], v[172:175], 0
    ds_read_b128 v[184:187], v17 offset:2240
    v_mfma_f32_16x16x32_f16 v[76:79], v[108:111], v[168:171], v[76:79]
    ds_read_b128 v[124:127], v16 offset:14848
    v_mfma_f32_16x16x32_f16 v[80:83], v[108:111], v[172:175], 0
    ds_read_b128 v[188:191], v17 offset:2752
    s_waitcnt lgkmcnt(6)
    v_mfma_f32_16x16x32_f16 v[80:83], v[104:107], v[176:179], v[80:83]
    ds_read_b128 v[128:131], v16 offset:15360
    v_mfma_f32_16x16x32_f16 v[80:83], v[112:115], v[168:171], v[80:83]
    ds_read_b128 v[192:195], v17 offset:3264
    v_mfma_f32_16x16x32_f16 v[84:87], v[108:111], v[176:179], 0
    ds_read_b128 v[132:135], v16 offset:15872
    v_mfma_f32_16x16x32_f16 v[84:87], v[112:115], v[172:175], v[84:87]
    ds_read_b128 v[196:199], v17 offset:3776
    v_mfma_f32_16x16x32_f16 v[88:91], v[112:115], v[176:179], 0
    s_waitcnt lgkmcnt(8)
    v_mfma_f32_16x16x32_f16 v[84:87], v[104:107], v[180:183], v[84:87]
    ds_read_b128 v[136:139], v16 offset:12352
    v_mfma_f32_16x16x32_f16 v[84:87], v[116:119], v[168:171], v[84:87]
    v_mfma_f32_16x16x32_f16 v[88:91], v[108:111], v[180:183], v[88:91]
    ds_read_b128 v[200:203], v17 offset:128
    v_mfma_f32_16x16x32_f16 v[88:91], v[116:119], v[172:175], v[88:91]
    v_mfma_f32_16x16x32_f16 v[92:95], v[112:115], v[180:183], 0
    ds_read_b128 v[140:143], v16 offset:12864
    v_mfma_f32_16x16x32_f16 v[92:95], v[116:119], v[176:179], v[92:95]
    v_mfma_f32_16x16x32_f16 v[96:99], v[116:119], v[180:183], 0
    ds_read_b128 v[204:207], v17 offset:640
    s_waitcnt lgkmcnt(10)
    v_mfma_f32_16x16x32_f16 v[88:91], v[104:107], v[184:187], v[88:91]
    v_mfma_f32_16x16x32_f16 v[88:91], v[120:123], v[168:171], v[88:91]
    ds_read_b128 v[144:147], v16 offset:13376
    v_mfma_f32_16x16x32_f16 v[92:95], v[108:111], v[184:187], v[92:95]
    v_mfma_f32_16x16x32_f16 v[92:95], v[120:123], v[172:175], v[92:95]
    ds_read_b128 v[208:211], v17 offset:1152
    v_mfma_f32_16x16x32_f16 v[96:99], v[112:115], v[184:187], v[96:99]
    v_mfma_f32_16x16x32_f16 v[96:99], v[120:123], v[176:179], v[96:99]
    ds_read_b128 v[148:151], v16 offset:13888
    v_mfma_f32_16x16x32_f16 v[100:103], v[116:119], v[184:187], 0
    v_mfma_f32_16x16x32_f16 v[100:103], v[120:123], v[180:183], v[100:103]
    ds_read_b128 v[212:215], v17 offset:1664
    s_waitcnt lgkmcnt(12)
    v_mfma_f32_16x16x32_f16 v[92:95], v[104:107], v[188:191], v[92:95]
    v_mfma_f32_16x16x32_f16 v[92:95], v[124:127], v[168:171], v[92:95]
    ds_read_b128 v[152:155], v16 offset:14400
    v_mfma_f32_16x16x32_f16 v[96:99], v[108:111], v[188:191], v[96:99]
    v_mfma_f32_16x16x32_f16 v[96:99], v[124:127], v[172:175], v[96:99]
    ds_read_b128 v[216:219], v17 offset:2176
    v_mfma_f32_16x16x32_f16 v[100:103], v[112:115], v[188:191], v[100:103]
    v_mfma_f32_16x16x32_f16 v[100:103], v[124:127], v[176:179], v[100:103]
    ds_read_b128 v[156:159], v16 offset:14912
    s_waitcnt lgkmcnt(13)
    v_mfma_f32_16x16x32_f16 v[96:99], v[104:107], v[192:195], v[96:99]
    v_mfma_f32_16x16x32_f16 v[96:99], v[128:131], v[168:171], v[96:99]
    ds_read_b128 v[220:223], v17 offset:2688
    v_mfma_f32_16x16x32_f16 v[100:103], v[108:111], v[192:195], v[100:103]
    v_mfma_f32_16x16x32_f16 v[100:103], v[128:131], v[172:175], v[100:103]
    ds_read_b128 v[160:163], v16 offset:15424
    s_waitcnt lgkmcnt(13)
    v_mfma_f32_16x16x32_f16 v[100:103], v[104:107], v[196:199], v[100:103]
    v_mfma_f32_16x16x32_f16 v[100:103], v[132:135], v[168:171], v[100:103]
    ds_read_b128 v[224:227], v17 offset:3200
    s_waitcnt lgkmcnt(12)
    v_mfma_f32_16x16x32_f16 v[72:75], v[136:139], v[200:203], v[72:75]
    ds_read_b128 v[164:167], v16 offset:15936
    s_waitcnt lgkmcnt(11)
    v_mfma_f32_16x16x32_f16 v[76:79], v[136:139], v[204:207], v[76:79]
    ds_read_b128 v[228:231], v17 offset:3712
    v_mfma_f32_16x16x32_f16 v[76:79], v[140:143], v[200:203], v[76:79]
    v_mfma_f32_16x16x32_f16 v[80:83], v[140:143], v[204:207], v[80:83]
    s_waitcnt lgkmcnt(10)
    v_mfma_f32_16x16x32_f16 v[80:83], v[136:139], v[208:211], v[80:83]
    v_mfma_f32_16x16x32_f16 v[80:83], v[144:147], v[200:203], v[80:83]
    ds_read_b128 v[104:107], v16 offset:12416
    v_mfma_f32_16x16x32_f16 v[84:87], v[140:143], v[208:211], v[84:87]
    v_mfma_f32_16x16x32_f16 v[84:87], v[144:147], v[204:207], v[84:87]
    ds_read_b128 v[168:171], v17 offset:64
    v_mfma_f32_16x16x32_f16 v[88:91], v[144:147], v[208:211], v[88:91]
    s_waitcnt lgkmcnt(10)
    v_mfma_f32_16x16x32_f16 v[84:87], v[136:139], v[212:215], v[84:87]
    ds_read_b128 v[108:111], v16 offset:12928
    v_mfma_f32_16x16x32_f16 v[84:87], v[148:151], v[200:203], v[84:87]
    v_mfma_f32_16x16x32_f16 v[88:91], v[140:143], v[212:215], v[88:91]
    ds_read_b128 v[172:175], v17 offset:576
    v_mfma_f32_16x16x32_f16 v[88:91], v[148:151], v[204:207], v[88:91]
    v_mfma_f32_16x16x32_f16 v[92:95], v[144:147], v[212:215], v[92:95]
    ds_read_b128 v[112:115], v16 offset:13440
    v_mfma_f32_16x16x32_f16 v[92:95], v[148:151], v[208:211], v[92:95]
    v_mfma_f32_16x16x32_f16 v[96:99], v[148:151], v[212:215], v[96:99]
    ds_read_b128 v[176:179], v17 offset:1088
    s_waitcnt lgkmcnt(12)
    v_mfma_f32_16x16x32_f16 v[88:91], v[136:139], v[216:219], v[88:91]
    v_mfma_f32_16x16x32_f16 v[88:91], v[152:155], v[200:203], v[88:91]
    ds_read_b128 v[116:119], v16 offset:13952
    v_mfma_f32_16x16x32_f16 v[92:95], v[140:143], v[216:219], v[92:95]
    v_mfma_f32_16x16x32_f16 v[92:95], v[152:155], v[204:207], v[92:95]
    ds_read_b128 v[180:183], v17 offset:1600
    v_mfma_f32_16x16x32_f16 v[96:99], v[144:147], v[216:219], v[96:99]
    v_mfma_f32_16x16x32_f16 v[96:99], v[152:155], v[208:211], v[96:99]
    ds_read_b128 v[120:123], v16 offset:14464
    v_mfma_f32_16x16x32_f16 v[100:103], v[148:151], v[216:219], v[100:103]
    v_mfma_f32_16x16x32_f16 v[100:103], v[152:155], v[212:215], v[100:103]
    ds_read_b128 v[184:187], v17 offset:2112
    s_waitcnt lgkmcnt(14)
    v_mfma_f32_16x16x32_f16 v[92:95], v[136:139], v[220:223], v[92:95]
    v_mfma_f32_16x16x32_f16 v[92:95], v[156:159], v[200:203], v[92:95]
    ds_read_b128 v[124:127], v16 offset:14976
    v_mfma_f32_16x16x32_f16 v[96:99], v[140:143], v[220:223], v[96:99]
    v_mfma_f32_16x16x32_f16 v[96:99], v[156:159], v[204:207], v[96:99]
    ds_read_b128 v[188:191], v17 offset:2624
    v_mfma_f32_16x16x32_f16 v[100:103], v[144:147], v[220:223], v[100:103]
    v_mfma_f32_16x16x32_f16 v[100:103], v[156:159], v[208:211], v[100:103]
    ds_read_b128 v[128:131], v16 offset:15488
    s_waitcnt lgkmcnt(15)
    v_mfma_f32_16x16x32_f16 v[96:99], v[136:139], v[224:227], v[96:99]
    v_mfma_f32_16x16x32_f16 v[96:99], v[160:163], v[200:203], v[96:99]
    ds_read_b128 v[192:195], v17 offset:3136
    v_mfma_f32_16x16x32_f16 v[100:103], v[140:143], v[224:227], v[100:103]
    v_mfma_f32_16x16x32_f16 v[100:103], v[160:163], v[204:207], v[100:103]
    ds_read_b128 v[132:135], v16 offset:16000
    s_waitcnt lgkmcnt(15)
    v_mfma_f32_16x16x32_f16 v[100:103], v[136:139], v[228:231], v[100:103]
    v_mfma_f32_16x16x32_f16 v[100:103], v[164:167], v[200:203], v[100:103]
    ds_read_b128 v[196:199], v17 offset:3648
    s_waitcnt lgkmcnt(14)
    v_mfma_f32_16x16x32_f16 v[72:75], v[104:107], v[168:171], v[72:75]
    s_waitcnt lgkmcnt(12)
    v_mfma_f32_16x16x32_f16 v[76:79], v[104:107], v[172:175], v[76:79]
    v_mfma_f32_16x16x32_f16 v[76:79], v[108:111], v[168:171], v[76:79]
    v_mfma_f32_16x16x32_f16 v[80:83], v[108:111], v[172:175], v[80:83]
    s_waitcnt lgkmcnt(10)
    v_mfma_f32_16x16x32_f16 v[80:83], v[104:107], v[176:179], v[80:83]
    v_mfma_f32_16x16x32_f16 v[80:83], v[112:115], v[168:171], v[80:83]
    ds_read_b128 v[136:139], v16 offset:12480
    v_mfma_f32_16x16x32_f16 v[84:87], v[108:111], v[176:179], v[84:87]
    v_mfma_f32_16x16x32_f16 v[84:87], v[112:115], v[172:175], v[84:87]
    ds_read_b128 v[200:203], v17 offset:0
    v_mfma_f32_16x16x32_f16 v[88:91], v[112:115], v[176:179], v[88:91]
    s_waitcnt lgkmcnt(10)
    v_mfma_f32_16x16x32_f16 v[84:87], v[104:107], v[180:183], v[84:87]
    ds_read_b128 v[140:143], v16 offset:12992
    v_mfma_f32_16x16x32_f16 v[84:87], v[116:119], v[168:171], v[84:87]
    v_mfma_f32_16x16x32_f16 v[88:91], v[108:111], v[180:183], v[88:91]
    ds_read_b128 v[204:207], v17 offset:512
    v_mfma_f32_16x16x32_f16 v[88:91], v[116:119], v[172:175], v[88:91]
    v_mfma_f32_16x16x32_f16 v[92:95], v[112:115], v[180:183], v[92:95]
    ds_read_b128 v[144:147], v16 offset:13504
    v_mfma_f32_16x16x32_f16 v[92:95], v[116:119], v[176:179], v[92:95]
    v_mfma_f32_16x16x32_f16 v[96:99], v[116:119], v[180:183], v[96:99]
    ds_read_b128 v[208:211], v17 offset:1024
    s_waitcnt lgkmcnt(12)
    v_mfma_f32_16x16x32_f16 v[88:91], v[104:107], v[184:187], v[88:91]
    v_mfma_f32_16x16x32_f16 v[88:91], v[120:123], v[168:171], v[88:91]
    ds_read_b128 v[148:151], v16 offset:14016
    v_mfma_f32_16x16x32_f16 v[92:95], v[108:111], v[184:187], v[92:95]
    v_mfma_f32_16x16x32_f16 v[92:95], v[120:123], v[172:175], v[92:95]
    ds_read_b128 v[212:215], v17 offset:1536
    v_mfma_f32_16x16x32_f16 v[96:99], v[112:115], v[184:187], v[96:99]
    v_mfma_f32_16x16x32_f16 v[96:99], v[120:123], v[176:179], v[96:99]
    ds_read_b128 v[152:155], v16 offset:14528
    v_mfma_f32_16x16x32_f16 v[100:103], v[116:119], v[184:187], v[100:103]
    v_mfma_f32_16x16x32_f16 v[100:103], v[120:123], v[180:183], v[100:103]
    ds_read_b128 v[216:219], v17 offset:2048
    s_waitcnt lgkmcnt(14)
    v_mfma_f32_16x16x32_f16 v[92:95], v[104:107], v[188:191], v[92:95]
    v_mfma_f32_16x16x32_f16 v[92:95], v[124:127], v[168:171], v[92:95]
    ds_read_b128 v[156:159], v16 offset:15040
    v_mfma_f32_16x16x32_f16 v[96:99], v[108:111], v[188:191], v[96:99]
    v_mfma_f32_16x16x32_f16 v[96:99], v[124:127], v[172:175], v[96:99]
    ds_read_b128 v[220:223], v17 offset:2560
    v_mfma_f32_16x16x32_f16 v[100:103], v[112:115], v[188:191], v[100:103]
    v_mfma_f32_16x16x32_f16 v[100:103], v[124:127], v[176:179], v[100:103]
    ds_read_b128 v[160:163], v16 offset:15552
    s_waitcnt lgkmcnt(15)
    v_mfma_f32_16x16x32_f16 v[96:99], v[104:107], v[192:195], v[96:99]
    v_mfma_f32_16x16x32_f16 v[96:99], v[128:131], v[168:171], v[96:99]
    ds_read_b128 v[224:227], v17 offset:3072
    v_mfma_f32_16x16x32_f16 v[100:103], v[108:111], v[192:195], v[100:103]
    v_mfma_f32_16x16x32_f16 v[100:103], v[128:131], v[172:175], v[100:103]
    ds_read_b128 v[164:167], v16 offset:16064
    s_waitcnt lgkmcnt(15)
    v_mfma_f32_16x16x32_f16 v[100:103], v[104:107], v[196:199], v[100:103]
    v_mfma_f32_16x16x32_f16 v[100:103], v[132:135], v[168:171], v[100:103]
    ds_read_b128 v[228:231], v17 offset:3584
    s_waitcnt lgkmcnt(14)
    v_mfma_f32_16x16x32_f16 v[72:75], v[136:139], v[200:203], v[72:75]
    s_waitcnt lgkmcnt(12)
    v_mfma_f32_16x16x32_f16 v[76:79], v[136:139], v[204:207], v[76:79]
    v_mfma_f32_16x16x32_f16 v[76:79], v[140:143], v[200:203], v[76:79]
    v_mfma_f32_16x16x32_f16 v[80:83], v[140:143], v[204:207], v[80:83]
    s_waitcnt lgkmcnt(10)
    v_mfma_f32_16x16x32_f16 v[80:83], v[136:139], v[208:211], v[80:83]
    v_mfma_f32_16x16x32_f16 v[80:83], v[144:147], v[200:203], v[80:83]
    ds_read_b64 v[20:21], v62 offset:512
    v_mfma_f32_16x16x32_f16 v[84:87], v[140:143], v[208:211], v[84:87]
    v_mfma_f32_16x16x32_f16 v[84:87], v[144:147], v[204:207], v[84:87]
    ds_read_b64 v[22:23], v62 offset:1024
    v_mfma_f32_16x16x32_f16 v[88:91], v[144:147], v[208:211], v[88:91]
    s_waitcnt lgkmcnt(10)
    v_mfma_f32_16x16x32_f16 v[84:87], v[136:139], v[212:215], v[84:87]
    ds_read_b64 v[24:25], v62 offset:1536
    v_mfma_f32_16x16x32_f16 v[84:87], v[148:151], v[200:203], v[84:87]
    v_mfma_f32_16x16x32_f16 v[88:91], v[140:143], v[212:215], v[88:91]
    ds_read_b64 v[26:27], v62 offset:2048
    v_mfma_f32_16x16x32_f16 v[88:91], v[148:151], v[204:207], v[88:91]
    v_mfma_f32_16x16x32_f16 v[92:95], v[144:147], v[212:215], v[92:95]
    v_mfma_f32_16x16x32_f16 v[92:95], v[148:151], v[208:211], v[92:95]
    v_mfma_f32_16x16x32_f16 v[96:99], v[148:151], v[212:215], v[96:99]
    s_waitcnt lgkmcnt(10)
    v_mfma_f32_16x16x32_f16 v[88:91], v[136:139], v[216:219], v[88:91]
    v_mfma_f32_16x16x32_f16 v[88:91], v[152:155], v[200:203], v[88:91]
    v_mfma_f32_16x16x32_f16 v[92:95], v[140:143], v[216:219], v[92:95]
    v_mfma_f32_16x16x32_f16 v[92:95], v[152:155], v[204:207], v[92:95]
    v_mfma_f32_16x16x32_f16 v[96:99], v[144:147], v[216:219], v[96:99]
    v_mfma_f32_16x16x32_f16 v[96:99], v[152:155], v[208:211], v[96:99]
    v_mfma_f32_16x16x32_f16 v[100:103], v[148:151], v[216:219], v[100:103]
    v_mfma_f32_16x16x32_f16 v[100:103], v[152:155], v[212:215], v[100:103]
    s_waitcnt lgkmcnt(8)
    v_mfma_f32_16x16x32_f16 v[92:95], v[136:139], v[220:223], v[92:95]
    v_mfma_f32_16x16x32_f16 v[92:95], v[156:159], v[200:203], v[92:95]
    v_mfma_f32_16x16x32_f16 v[96:99], v[140:143], v[220:223], v[96:99]
    v_mfma_f32_16x16x32_f16 v[96:99], v[156:159], v[204:207], v[96:99]
    v_mfma_f32_16x16x32_f16 v[100:103], v[144:147], v[220:223], v[100:103]
    v_mfma_f32_16x16x32_f16 v[100:103], v[156:159], v[208:211], v[100:103]
    s_waitcnt lgkmcnt(6)
    v_mfma_f32_16x16x32_f16 v[96:99], v[136:139], v[224:227], v[96:99]
    v_mfma_f32_16x16x32_f16 v[96:99], v[160:163], v[200:203], v[96:99]
    v_mfma_f32_16x16x32_f16 v[100:103], v[140:143], v[224:227], v[100:103]
    v_mfma_f32_16x16x32_f16 v[100:103], v[160:163], v[204:207], v[100:103]
    s_waitcnt lgkmcnt(4)
    v_mfma_f32_16x16x32_f16 v[100:103], v[136:139], v[228:231], v[100:103]
    v_mfma_f32_16x16x32_f16 v[100:103], v[164:167], v[200:203], v[100:103]
    s_lshl_b32 s60, s3, 12
    v_add_u32 v5, s60, v8
    s_xor_b32 s60, s60, 4096
    v_add_u32 v6, s60, v8
    s_cmp_eq_u32 s58, 0
    s_barrier
    s_cbranch_scc1 L_b_e0
    ds_write_b128 v5, v[72:75] offset:12288
    ds_write_b128 v5, v[76:79] offset:13312
    ds_write_b128 v5, v[80:83] offset:14336
    ds_write_b128 v5, v[84:87] offset:15360
    v_mov_b32 v72, v88
    v_mov_b32 v73, v89
    v_mov_b32 v74, v90
    v_mov_b32 v75, v91
    v_mov_b32 v76, v92
    v_mov_b32 v77, v93
    v_mov_b32 v78, v94
    v_mov_b32 v79, v95
    v_mov_b32 v80, v96
    v_mov_b32 v81, v97
    v_mov_b32 v82, v98
    v_mov_b32 v83, v99
    v_mov_b32 v84, v100
    v_mov_b32 v85, v101
    v_mov_b32 v86, v102
    v_mov_b32 v87, v103
    s_branch L_b_e1
L_b_e0:
    ds_write_b128 v5, v[88:91] offset:12288
    ds_write_b128 v5, v[92:95] offset:13312
    ds_write_b128 v5, v[96:99] offset:14336
    ds_write_b128 v5, v[100:103] offset:15360
L_b_e1:
    s_waitcnt lgkmcnt(4)
    v_fma_mix_f32 v200, v20, v10, 0 op_sel:[0,0,0] op_sel_hi:[1,0,0]
    v_fma_mix_f32 v201, v20, v10, 0 op_sel:[1,0,0] op_sel_hi:[1,0,0]
    v_fma_mix_f32 v202, v21, v10, 0 op_sel:[0,0,0] op_sel_hi:[1,0,0]
    v_fma_mix_f32 v203, v21, v10, 0 op_sel:[1,0,0] op_sel_hi:[1,0,0]
    v_fma_mix_f32 v204, v22, v10, 0 op_sel:[0,0,0] op_sel_hi:[1,0,0]
    v_fma_mix_f32 v205, v22, v10, 0 op_sel:[1,0,0] op_sel_hi:[1,0,0]
    v_fma_mix_f32 v206, v23, v10, 0 op_sel:[0,0,0] op_sel_hi:[1,0,0]
    v_fma_mix_f32 v207, v23, v10, 0 op_sel:[1,0,0] op_sel_hi:[1,0,0]
    v_fma_mix_f32 v208, v24, v10, 0 op_sel:[0,0,0] op_sel_hi:[1,0,0]
    v_fma_mix_f32 v209, v24, v10, 0 op_sel:[1,0,0] op_sel_hi:[1,0,0]
    v_fma_mix_f32 v210, v25, v10, 0 op_sel:[0,0,0] op_sel_hi:[1,0,0]
    v_fma_mix_f32 v211, v25, v10, 0 op_sel:[1,0,0] op_sel_hi:[1,0,0]
    v_fma_mix_f32 v212, v26, v10, 0 op_sel:[0,0,0] op_sel_hi:[1,0,0]
    v_fma_mix_f32 v213, v26, v10, 0 op_sel:[1,0,0] op_sel_hi:[1,0,0]
    v_fma_mix_f32 v214, v27, v10, 0 op_sel:[0,0,0] op_sel_hi:[1,0,0]
    v_fma_mix_f32 v215, v27, v10, 0 op_sel:[1,0,0] op_sel_hi:[1,0,0]
    s_waitcnt lgkmcnt(0)
    s_barrier
    ds_read_b128 v[104:107], v6 offset:12288
    ds_read_b128 v[108:111], v6 offset:13312
    ds_read_b128 v[112:115], v6 offset:14336
    ds_read_b128 v[116:119], v6 offset:15360
    s_waitcnt lgkmcnt(3)
    v_add_f32 v72, v72, v104
    v_add_f32 v73, v73, v105
    v_add_f32 v74, v74, v106
    v_add_f32 v75, v75, v107
    v_fma_f32 v72, v72, v18, v200
    v_fma_f32 v73, v73, v18, v201
    v_fma_f32 v74, v74, v18, v202
    v_fma_f32 v75, v75, v18, v203
    v_cvt_pk_bf16_f32 v168, v72, v73
    v_cvt_pk_bf16_f32 v169, v74, v75
    s_waitcnt lgkmcnt(2)
    v_add_f32 v76, v76, v108
    v_add_f32 v77, v77, v109
    v_add_f32 v78, v78, v110
    v_add_f32 v79, v79, v111
    v_fma_f32 v76, v76, v18, v204
    v_fma_f32 v77, v77, v18, v205
    v_fma_f32 v78, v78, v18, v206
    v_fma_f32 v79, v79, v18, v207
    v_cvt_pk_bf16_f32 v170, v76, v77
    v_cvt_pk_bf16_f32 v171, v78, v79
    s_nop 0
    v_permlane16_swap_b32 v168, v170
    v_permlane16_swap_b32 v169, v171
    buffer_store_dwordx4 v[168:171], v63, s[4:7], s56 offen offset:0 sc1
    s_waitcnt lgkmcnt(1)
    v_add_f32 v80, v80, v112
    v_add_f32 v81, v81, v113
    v_add_f32 v82, v82, v114
    v_add_f32 v83, v83, v115
    v_fma_f32 v80, v80, v18, v208
    v_fma_f32 v81, v81, v18, v209
    v_fma_f32 v82, v82, v18, v210
    v_fma_f32 v83, v83, v18, v211
    v_cvt_pk_bf16_f32 v172, v80, v81
    v_cvt_pk_bf16_f32 v173, v82, v83
    s_waitcnt lgkmcnt(0)
    v_add_f32 v84, v84, v116
    v_add_f32 v85, v85, v117
    v_add_f32 v86, v86, v118
    v_add_f32 v87, v87, v119
    v_fma_f32 v84, v84, v18, v212
    v_fma_f32 v85, v85, v18, v213
    v_fma_f32 v86, v86, v18, v214
    v_fma_f32 v87, v87, v18, v215
    v_cvt_pk_bf16_f32 v174, v84, v85
    v_cvt_pk_bf16_f32 v175, v86, v87
    s_nop 0
    v_permlane16_swap_b32 v172, v174
    v_permlane16_swap_b32 v173, v175
    buffer_store_dwordx4 v[172:175], v63, s[4:7], s56 offen offset:1024 sc1
    v_mov_b32 v6, s50
    v_mov_b32 v7, s51
    s_lshl_b32 s60, s63, 1
    s_add_u32 s60, s60, s58
    s_lshl_b32 s60, s60, 6
    s_add_u32 s60, s60, 458752
    v_mov_b32 v5, 0
    s_waitcnt vmcnt(0)
    s_mov_b64 exec, 1
    buffer_store_dwordx2 v[6:7], v5, s[4:7], s60 offen sc1
    s_mov_b64 exec, -1
    s_or_b32 s60, s2, s3
    s_cmp_lg_u32 s60, 0
    s_cbranch_scc1 L_b_done
    v_lshlrev_b32 v7, 8, v1
    s_mov_b32 s62, 0
L_b_gpoll:
    s_mov_b32 s60, 4096
    buffer_load_dwordx2 v[136:137], v7, s[4:7], s60 offen sc1
    s_mov_b32 s60, 20480
    buffer_load_dwordx2 v[138:139], v7, s[4:7], s60 offen sc1
    s_mov_b32 s60, 36864
    buffer_load_dwordx2 v[140:141], v7, s[4:7], s60 offen sc1
    s_mov_b32 s60, 53248
    buffer_load_dwordx2 v[142:143], v7, s[4:7], s60 offen sc1
    s_waitcnt vmcnt(0)
    v_mov_b32 v4, 0
    v_xor_b32 v5, s50, v136
    v_xor_b32 v6, s51, v137
    v_or3_b32 v4, v4, v5, v6
    v_xor_b32 v5, s50, v138
    v_xor_b32 v6, s51, v139
    v_or3_b32 v4, v4, v5, v6
    v_xor_b32 v5, s50, v140
    v_xor_b32 v6, s51, v141
    v_or3_b32 v4, v4, v5, v6
    v_xor_b32 v5, s50, v142
    v_xor_b32 v6, s51, v143
    v_or3_b32 v4, v4, v5, v6
    v_cmp_ne_u32 vcc, 0, v4
    s_add_u32 s62, s62, 1
    s_cmp_eq_u64 vcc, 0
    s_cbranch_scc1 L_b_gok
    s_cmp_ge_u32 s62, 200000
    s_cbranch_scc1 L_b_gok
    s_sleep 8
    s_branch L_b_gpoll
L_b_gok:
    v_mov_b32 v4, s50
    v_mov_b32 v5, 0
    s_mov_b64 exec, 1
    buffer_store_dword v4, v5, s[4:7], 0 offen offset:0
    s_mov_b64 exec, -1
L_b_done:
    s_endpgm
L_role_A:
    s_setprio 2
    s_sub_u32 s60, s2, 256
    s_and_b32 s61, s60, 7
    s_lshr_b32 s62, s60, 3
    s_mov_b32 s8, s16
    s_mov_b32 s9, s17
    s_mov_b32 s10, 2097152
    s_mov_b32 s11, 0x20000
    s_mov_b32 s12, s36
    s_mov_b32 s13, s37
    s_mov_b32 s14, 1835008
    s_mov_b32 s15, 0x20000
    s_mul_i32 s71, s3, 20480
    v_lshrrev_b32 v4, 3, v1
    v_and_b32 v5, 7, v1
    v_mul_u32_u24 v160, 3584, v4
    v_bfe_u32 v6, v1, 4, 1
    v_lshlrev_b32 v6, 2, v6
    v_xor_b32 v6, v5, v6
    v_lshl_add_u32 v160, v6, 4, v160
    v_add_u32 v161, 27648, v160
    s_cmp_ge_u32 s62, 28
    s_cbranch_scc1 L_a_nog1
    s_mul_i32 s63, s62, 37
    s_lshr_b32 s63, s63, 8
    s_mul_i32 s64, s63, 7
    s_sub_u32 s64, s62, s64
    s_lshr_b32 s65, s61, 1
    s_lshl_b32 s65, s65, 2
    s_add_u32 s63, s63, s65
    s_and_b32 s65, s61, 1
    s_mul_i32 s65, s65, 7
    s_add_u32 s64, s64, s65
    v_lshrrev_b32 v6, 4, v1
    v_xor_b32 v6, v5, v6
    v_lshlrev_b32 v6, 4, v6
    v_lshl_add_u32 v156, v4, 10, v6
    v_xor_b32 v157, 64, v156
    v_add_u32 v157, 7168, v157
    v_add_u32 v158, 14336, v156
    v_add_u32 v159, 14336, v157
    s_lshl_b32 s68, s63, 17
    s_lshl_b32 s65, s3, 15
    s_add_u32 s68, s68, s65
    s_add_u32 s69, s62, s61
    s_and_b32 s69, s69, 7
    s_lshl_b32 s65, s69, 7
    s_add_u32 s77, s68, s65
    s_mul_i32 s70, s3, 57344
    s_lshl_b32 s65, s64, 8
    s_add_u32 s70, s70, s65
    s_add_u32 m0, s71, 0
    s_xor_b32 s35, s77, 0
    buffer_load_dwordx4 v156, s[8:11], s35 offen offset:0 lds
    buffer_load_dwordx4 v157, s[8:11], s35 offen offset:1024 lds
    buffer_load_dwordx4 v158, s[8:11], s35 offen offset:2048 lds
    buffer_load_dwordx4 v159, s[8:11], s35 offen offset:3072 lds
    s_add_u32 m0, s71, 12288
    s_xor_b32 s65, s69, 0
    s_mul_i32 s65, s65, 229376
    s_add_u32 s18, s65, s70
    buffer_load_dwordx4 v160, s[12:15], s18 offen lds
    buffer_load_dwordx4 v161, s[12:15], s18 offen offset:1024 lds
    s_add_u32 m0, s71, 4096
    s_xor_b32 s35, s77, 128
    buffer_load_dwordx4 v156, s[8:11], s35 offen offset:0 lds
    buffer_load_dwordx4 v157, s[8:11], s35 offen offset:1024 lds
    buffer_load_dwordx4 v158, s[8:11], s35 offen offset:2048 lds
    buffer_load_dwordx4 v159, s[8:11], s35 offen offset:3072 lds
    s_add_u32 m0, s71, 14336
    s_xor_b32 s65, s69, 1
    s_mul_i32 s65, s65, 229376
    s_add_u32 s19, s65, s70
    buffer_load_dwordx4 v160, s[12:15], s19 offen lds
    buffer_load_dwordx4 v161, s[12:15], s19 offen offset:1024 lds
    s_add_u32 m0, s71, 8192
    s_xor_b32 s35, s77, 256
    buffer_load_dwordx4 v156, s[8:11], s35 offen offset:0 lds
    buffer_load_dwordx4 v157, s[8:11], s35 offen offset:1024 lds
    buffer_load_dwordx4 v158, s[8:11], s35 offen offset:2048 lds
    buffer_load_dwordx4 v159, s[8:11], s35 offen offset:3072 lds
    s_add_u32 m0, s71, 16384
    s_xor_b32 s65, s69, 2
    s_mul_i32 s65, s65, 229376
    s_add_u32 s20, s65, s70
    buffer_load_dwordx4 v160, s[12:15], s20 offen lds
    buffer_load_dwordx4 v161, s[12:15], s20 offen offset:1024 lds
    s_mov_b32 s52, s40
    s_mov_b32 s53, s41
    s_mov_b32 s54, 1835008
    s_mov_b32 s55, 0x20000
    s_mov_b32 s56, s44
    s_mov_b32 s57, s45
    s_mov_b32 s58, 2097152
    s_mov_b32 s59, 0x20000
    s_lshl_b32 s78, s61, 2
    s_lshr_b32 s65, s62, 3
    s_add_u32 s78, s78, s65
    s_and_b32 s79, s62, 7
    s_lshr_b32 s66, s3, 1
    s_and_b32 s67, s3, 1
    v_lshrrev_b32 v4, 3, v1
    v_lshlrev_b32 v20, 10, v4
    v_and_b32 v4, 7, v1
    v_bfe_u32 v5, v1, 4, 1
    v_lshlrev_b32 v5, 1, v5
    v_xor_b32 v4, v4, v5
    v_lshl_add_u32 v20, v4, 4, v20
    v_add_u32 v21, 7168, v20
    s_lshl_b32 s73, s3, 14
    s_lshl_b32 s65, s79, 7
    s_add_u32 s73, s73, s65
    v_lshlrev_b32 v22, 4, v1
    v_lshrrev_b32 v4, 5, v1
    v_lshlrev_b32 v4, 10, v4
    v_bfe_u32 v5, v1, 2, 2
    v_lshl_add_u32 v4, v5, 7, v4
    v_bfe_u32 v5, v1, 4, 1
    v_lshl_add_u32 v4, v5, 5, v4
    v_and_b32 v5, 3, v1
    v_lshl_add_u32 v4, v5, 3, v4
    v_bfe_u32 v5, v1, 3, 1
    v_lshl_add_u32 v16, v5, 6, v4
    v_xor_b32 v17, 64, v16
    v_add_u32 v18, 20480, v16
    v_add_u32 v19, 20480, v17
    v_and_b32 v4, 31, v1
    v_lshlrev_b32 v23, 4, v4
    v_bfe_u32 v5, v1, 1, 3
    v_lshrrev_b32 v6, 5, v1
    v_xor_b32 v5, v5, v6
    v_lshlrev_b32 v5, 4, v5
    v_lshl_add_u32 v5, v4, 7, v5
    v_add_u32 v152, s71, v5
    v_xor_b32 v153, 32, v152
    v_xor_b32 v154, 64, v152
    v_xor_b32 v155, 96, v152
    s_lshr_b32 s72, s68, 6
    s_add_u32 s72, s72, 196608
    s_lshl_b32 s76, s64, 12
    s_add_u32 s76, s76, 262144
    s_waitcnt vmcnt(18)
    v_readfirstlane_b32 s50, v2
    s_nop 0
    s_mul_i32 s50, s50, 0x9E3779B1
    s_add_u32 s50, s50, 0x7F4A7C15
    s_xor_b32 s51, s50, 0x5bd1e995
    s_waitcnt vmcnt(14)
    ds_read_b128 v[24:27], v152 offset:0
    ds_read_b128 v[28:31], v153 offset:0
    ds_read_b128 v[32:35], v154 offset:0
    ds_read_b128 v[36:39], v155 offset:0
    s_waitcnt vmcnt(12)
    s_barrier
    ds_read_b64_tr_b16 v[232:233], v16 offset:12288
    ds_read_b64_tr_b16 v[234:235], v16 offset:12800
    ds_read_b64_tr_b16 v[236:237], v17 offset:12288
    ds_read_b64_tr_b16 v[238:239], v17 offset:12800
    ds_read_b64_tr_b16 v[240:241], v18 offset:12288
    ds_read_b64_tr_b16 v[242:243], v18 offset:12800
    ds_read_b64_tr_b16 v[244:245], v19 offset:12288
    ds_read_b64_tr_b16 v[246:247], v19 offset:12800
    s_waitcnt lgkmcnt(8)
    s_waitcnt lgkmcnt(4)
    v_mfma_f32_32x32x16_bf16 v[168:183], v[232:235], v[24:27], 0
    ds_read_b64_tr_b16 v[248:249], v16 offset:53248
    ds_read_b64_tr_b16 v[250:251], v16 offset:53760
    s_add_u32 m0, s71, 18432
    s_xor_b32 s65, s69, 3
    s_mul_i32 s65, s65, 229376
    s_add_u32 s21, s65, s70
    buffer_load_dwordx4 v160, s[12:15], s21 offen lds
    v_mfma_f32_32x32x16_bf16 v[184:199], v[236:239], v[24:27], 0
    ds_read_b64_tr_b16 v[252:253], v17 offset:53248
    ds_read_b64_tr_b16 v[254:255], v17 offset:53760
    buffer_load_dwordx4 v161, s[12:15], s21 offen offset:1024 lds
    s_waitcnt lgkmcnt(4)
    v_mfma_f32_32x32x16_bf16 v[168:183], v[240:243], v[28:31], v[168:183]
    ds_read_b64_tr_b16 v[232:233], v18 offset:53248
    ds_read_b64_tr_b16 v[234:235], v18 offset:53760
    s_add_u32 m0, s71, 0
    s_xor_b32 s35, s77, 384
    buffer_load_dwordx4 v156, s[8:11], s35 offen offset:0 lds
    v_mfma_f32_32x32x16_bf16 v[184:199], v[244:247], v[28:31], v[184:199]
    ds_read_b64_tr_b16 v[236:237], v19 offset:53248
    ds_read_b64_tr_b16 v[238:239], v19 offset:53760
    buffer_load_dwordx4 v157, s[8:11], s35 offen offset:1024 lds
    s_waitcnt vmcnt(10)
    s_barrier
    s_waitcnt lgkmcnt(4)
    v_mfma_f32_32x32x16_bf16 v[168:183], v[248:251], v[32:35], v[168:183]
    ds_read_b64_tr_b16 v[240:241], v16 offset:14336
    ds_read_b64_tr_b16 v[242:243], v16 offset:14848
    buffer_load_dwordx4 v158, s[8:11], s35 offen offset:2048 lds
    v_mfma_f32_32x32x16_bf16 v[184:199], v[252:255], v[32:35], v[184:199]
    ds_read_b64_tr_b16 v[244:245], v17 offset:14336
    ds_read_b64_tr_b16 v[246:247], v17 offset:14848
    buffer_load_dwordx4 v159, s[8:11], s35 offen offset:3072 lds
    s_waitcnt lgkmcnt(4)
    v_mfma_f32_32x32x16_bf16 v[168:183], v[232:235], v[36:39], v[168:183]
    ds_read_b64_tr_b16 v[248:249], v18 offset:14336
    ds_read_b64_tr_b16 v[250:251], v18 offset:14848
    ds_read_b128 v[40:43], v152 offset:4096
    ds_read_b128 v[44:47], v153 offset:4096
    v_mfma_f32_32x32x16_bf16 v[184:199], v[236:239], v[36:39], v[184:199]
    ds_read_b64_tr_b16 v[252:253], v19 offset:14336
    ds_read_b64_tr_b16 v[254:255], v19 offset:14848
    ds_read_b128 v[48:51], v154 offset:4096
    ds_read_b128 v[52:55], v155 offset:4096
    s_waitcnt lgkmcnt(0)
    v_mfma_f32_32x32x16_bf16 v[168:183], v[240:243], v[40:43], v[168:183]
    ds_read_b64_tr_b16 v[232:233], v16 offset:55296
    ds_read_b64_tr_b16 v[234:235], v16 offset:55808
    v_mfma_f32_32x32x16_bf16 v[184:199], v[244:247], v[40:43], v[184:199]
    ds_read_b64_tr_b16 v[236:237], v17 offset:55296
    ds_read_b64_tr_b16 v[238:239], v17 offset:55808
    s_waitcnt vmcnt(8)
    ds_read_b128 v[56:59], v152 offset:8192
    ds_read_b128 v[60:63], v153 offset:8192
    v_mfma_f32_32x32x16_bf16 v[168:183], v[248:251], v[44:47], v[168:183]
    ds_read_b64_tr_b16 v[240:241], v18 offset:55296
    ds_read_b64_tr_b16 v[242:243], v18 offset:55808
    ds_read_b128 v[64:67], v154 offset:8192
    ds_read_b128 v[68:71], v155 offset:8192
    v_mfma_f32_32x32x16_bf16 v[184:199], v[252:255], v[44:47], v[184:199]
    ds_read_b64_tr_b16 v[244:245], v19 offset:55296
    ds_read_b64_tr_b16 v[246:247], v19 offset:55808
    s_add_u32 m0, s71, 4096
    s_xor_b32 s35, s77, 512
    buffer_load_dwordx4 v156, s[8:11], s35 offen offset:0 lds
    s_waitcnt vmcnt(7)
    s_barrier
    s_waitcnt lgkmcnt(8)
    v_mfma_f32_32x32x16_bf16 v[168:183], v[232:235], v[48:51], v[168:183]
    ds_read_b64_tr_b16 v[248:249], v16 offset:16384
    ds_read_b64_tr_b16 v[250:251], v16 offset:16896
    buffer_load_dwordx4 v157, s[8:11], s35 offen offset:1024 lds
    v_mfma_f32_32x32x16_bf16 v[184:199], v[236:239], v[48:51], v[184:199]
    ds_read_b64_tr_b16 v[252:253], v17 offset:16384
    ds_read_b64_tr_b16 v[254:255], v17 offset:16896
    buffer_load_dwordx4 v158, s[8:11], s35 offen offset:2048 lds
    s_waitcnt lgkmcnt(4)
    v_mfma_f32_32x32x16_bf16 v[168:183], v[240:243], v[52:55], v[168:183]
    ds_read_b64_tr_b16 v[232:233], v18 offset:16384
    ds_read_b64_tr_b16 v[234:235], v18 offset:16896
    buffer_load_dwordx4 v159, s[8:11], s35 offen offset:3072 lds
    v_mfma_f32_32x32x16_bf16 v[184:199], v[244:247], v[52:55], v[184:199]
    ds_read_b64_tr_b16 v[236:237], v19 offset:16384
    ds_read_b64_tr_b16 v[238:239], v19 offset:16896
    s_waitcnt lgkmcnt(4)
    v_mfma_f32_32x32x16_bf16 v[168:183], v[248:251], v[56:59], v[168:183]
    ds_read_b64_tr_b16 v[240:241], v16 offset:57344
    ds_read_b64_tr_b16 v[242:243], v16 offset:57856
    s_add_u32 m0, s71, 12288
    s_xor_b32 s65, s69, 4
    s_mul_i32 s65, s65, 229376
    s_add_u32 s22, s65, s70
    buffer_load_dwordx4 v160, s[12:15], s22 offen lds
    v_mfma_f32_32x32x16_bf16 v[184:199], v[252:255], v[56:59], v[184:199]
    ds_read_b64_tr_b16 v[244:245], v17 offset:57344
    ds_read_b64_tr_b16 v[246:247], v17 offset:57856
    buffer_load_dwordx4 v161, s[12:15], s22 offen offset:1024 lds
    s_waitcnt lgkmcnt(4)
    v_mfma_f32_32x32x16_bf16 v[168:183], v[232:235], v[60:63], v[168:183]
    ds_read_b64_tr_b16 v[248:249], v18 offset:57344
    ds_read_b64_tr_b16 v[250:251], v18 offset:57856
    s_add_u32 m0, s71, 8192
    s_xor_b32 s35, s77, 640
    buffer_load_dwordx4 v156, s[8:11], s35 offen offset:0 lds
    v_mfma_f32_32x32x16_bf16 v[184:199], v[236:239], v[60:63], v[184:199]
    ds_read_b64_tr_b16 v[252:253], v19 offset:57344
    ds_read_b64_tr_b16 v[254:255], v19 offset:57856
    buffer_load_dwordx4 v157, s[8:11], s35 offen offset:1024 lds
    s_waitcnt vmcnt(12)
    s_barrier
    s_waitcnt lgkmcnt(4)
    v_mfma_f32_32x32x16_bf16 v[168:183], v[240:243], v[64:67], v[168:183]
    ds_read_b64_tr_b16 v[232:233], v16 offset:18432
    ds_read_b64_tr_b16 v[234:235], v16 offset:18944
    buffer_load_dwordx4 v158, s[8:11], s35 offen offset:2048 lds
    v_mfma_f32_32x32x16_bf16 v[184:199], v[244:247], v[64:67], v[184:199]
    ds_read_b64_tr_b16 v[236:237], v17 offset:18432
    ds_read_b64_tr_b16 v[238:239], v17 offset:18944
    buffer_load_dwordx4 v159, s[8:11], s35 offen offset:3072 lds
    s_waitcnt lgkmcnt(4)
    v_mfma_f32_32x32x16_bf16 v[168:183], v[248:251], v[68:71], v[168:183]
    ds_read_b64_tr_b16 v[240:241], v18 offset:18432
    ds_read_b64_tr_b16 v[242:243], v18 offset:18944
    s_waitcnt vmcnt(10)
    ds_read_b128 v[72:75], v152 offset:0
    ds_read_b128 v[76:79], v153 offset:0
    v_mfma_f32_32x32x16_bf16 v[184:199], v[252:255], v[68:71], v[184:199]
    ds_read_b64_tr_b16 v[244:245], v19 offset:18432
    ds_read_b64_tr_b16 v[246:247], v19 offset:18944
    ds_read_b128 v[80:83], v154 offset:0
    ds_read_b128 v[84:87], v155 offset:0
    s_waitcnt lgkmcnt(0)
    v_mfma_f32_32x32x16_bf16 v[168:183], v[232:235], v[72:75], v[168:183]
    ds_read_b64_tr_b16 v[248:249], v16 offset:59392
    ds_read_b64_tr_b16 v[250:251], v16 offset:59904
    v_mfma_f32_32x32x16_bf16 v[184:199], v[236:239], v[72:75], v[184:199]
    ds_read_b64_tr_b16 v[252:253], v17 offset:59392
    ds_read_b64_tr_b16 v[254:255], v17 offset:59904
    s_add_u32 m0, s71, 14336
    s_xor_b32 s65, s69, 5
    s_mul_i32 s65, s65, 229376
    s_add_u32 s23, s65, s70
    buffer_load_dwordx4 v160, s[12:15], s23 offen lds
    v_mfma_f32_32x32x16_bf16 v[168:183], v[240:243], v[76:79], v[168:183]
    ds_read_b64_tr_b16 v[232:233], v18 offset:59392
    ds_read_b64_tr_b16 v[234:235], v18 offset:59904
    buffer_load_dwordx4 v161, s[12:15], s23 offen offset:1024 lds
    v_mfma_f32_32x32x16_bf16 v[184:199], v[244:247], v[76:79], v[184:199]
    ds_read_b64_tr_b16 v[236:237], v19 offset:59392
    ds_read_b64_tr_b16 v[238:239], v19 offset:59904
    s_waitcnt vmcnt(8)
    ds_read_b128 v[88:91], v152 offset:4096
    ds_read_b128 v[92:95], v153 offset:4096
    s_waitcnt vmcnt(6)
    s_barrier
    s_waitcnt lgkmcnt(6)
    v_mfma_f32_32x32x16_bf16 v[168:183], v[248:251], v[80:83], v[168:183]
    ds_read_b64_tr_b16 v[240:241], v16 offset:12288
    ds_read_b64_tr_b16 v[242:243], v16 offset:12800
    ds_read_b128 v[96:99], v154 offset:4096
    ds_read_b128 v[100:103], v155 offset:4096
    v_mfma_f32_32x32x16_bf16 v[184:199], v[252:255], v[80:83], v[184:199]
    ds_read_b64_tr_b16 v[244:245], v17 offset:12288
    ds_read_b64_tr_b16 v[246:247], v17 offset:12800
    s_add_u32 m0, s71, 0
    s_xor_b32 s35, s77, 768
    buffer_load_dwordx4 v156, s[8:11], s35 offen offset:0 lds
    s_waitcnt lgkmcnt(8)
    v_mfma_f32_32x32x16_bf16 v[168:183], v[232:235], v[84:87], v[168:183]
    ds_read_b64_tr_b16 v[248:249], v18 offset:12288
    ds_read_b64_tr_b16 v[250:251], v18 offset:12800
    buffer_load_dwordx4 v157, s[8:11], s35 offen offset:1024 lds
    v_mfma_f32_32x32x16_bf16 v[184:199], v[236:239], v[84:87], v[184:199]
    ds_read_b64_tr_b16 v[252:253], v19 offset:12288
    ds_read_b64_tr_b16 v[254:255], v19 offset:12800
    buffer_load_dwordx4 v158, s[8:11], s35 offen offset:2048 lds
    s_waitcnt lgkmcnt(6)
    s_waitcnt lgkmcnt(4)
    v_mfma_f32_32x32x16_bf16 v[168:183], v[240:243], v[88:91], v[168:183]
    ds_read_b64_tr_b16 v[232:233], v16 offset:53248
    ds_read_b64_tr_b16 v[234:235], v16 offset:53760
    buffer_load_dwordx4 v159, s[8:11], s35 offen offset:3072 lds
    v_mfma_f32_32x32x16_bf16 v[184:199], v[244:247], v[88:91], v[184:199]
    ds_read_b64_tr_b16 v[236:237], v17 offset:53248
    ds_read_b64_tr_b16 v[238:239], v17 offset:53760
    s_waitcnt lgkmcnt(4)
    v_mfma_f32_32x32x16_bf16 v[168:183], v[248:251], v[92:95], v[168:183]
    ds_read_b64_tr_b16 v[240:241], v18 offset:53248
    ds_read_b64_tr_b16 v[242:243], v18 offset:53760
    s_add_u32 m0, s71, 16384
    s_xor_b32 s65, s69, 6
    s_mul_i32 s65, s65, 229376
    s_add_u32 s24, s65, s70
    buffer_load_dwordx4 v160, s[12:15], s24 offen lds
    v_mfma_f32_32x32x16_bf16 v[184:199], v[252:255], v[92:95], v[184:199]
    ds_read_b64_tr_b16 v[244:245], v19 offset:53248
    ds_read_b64_tr_b16 v[246:247], v19 offset:53760
    buffer_load_dwordx4 v161, s[12:15], s24 offen offset:1024 lds
    s_waitcnt vmcnt(6)
    s_barrier
    s_waitcnt lgkmcnt(4)
    v_mfma_f32_32x32x16_bf16 v[168:183], v[232:235], v[96:99], v[168:183]
    ds_read_b64_tr_b16 v[248:249], v16 offset:14336
    ds_read_b64_tr_b16 v[250:251], v16 offset:14848
    ds_read_b128 v[104:107], v152 offset:8192
    ds_read_b128 v[108:111], v153 offset:8192
    v_mfma_f32_32x32x16_bf16 v[184:199], v[236:239], v[96:99], v[184:199]
    ds_read_b64_tr_b16 v[252:253], v17 offset:14336
    ds_read_b64_tr_b16 v[254:255], v17 offset:14848
    ds_read_b128 v[112:115], v154 offset:8192
    ds_read_b128 v[116:119], v155 offset:8192
    s_waitcnt lgkmcnt(8)
    v_mfma_f32_32x32x16_bf16 v[168:183], v[240:243], v[100:103], v[168:183]
    ds_read_b64_tr_b16 v[232:233], v18 offset:14336
    ds_read_b64_tr_b16 v[234:235], v18 offset:14848
    s_add_u32 m0, s71, 4096
    s_xor_b32 s35, s77, 896
    buffer_load_dwordx4 v156, s[8:11], s35 offen offset:0 lds
    v_mfma_f32_32x32x16_bf16 v[184:199], v[244:247], v[100:103], v[184:199]
    ds_read_b64_tr_b16 v[236:237], v19 offset:14336
    ds_read_b64_tr_b16 v[238:239], v19 offset:14848
    buffer_load_dwordx4 v157, s[8:11], s35 offen offset:1024 lds
    s_waitcnt lgkmcnt(4)
    v_mfma_f32_32x32x16_bf16 v[168:183], v[248:251], v[104:107], v[168:183]
    ds_read_b64_tr_b16 v[240:241], v16 offset:55296
    ds_read_b64_tr_b16 v[242:243], v16 offset:55808
    buffer_load_dwordx4 v158, s[8:11], s35 offen offset:2048 lds
    v_mfma_f32_32x32x16_bf16 v[184:199], v[252:255], v[104:107], v[184:199]
    ds_read_b64_tr_b16 v[244:245], v17 offset:55296
    ds_read_b64_tr_b16 v[246:247], v17 offset:55808
    buffer_load_dwordx4 v159, s[8:11], s35 offen offset:3072 lds
    s_waitcnt lgkmcnt(4)
    v_mfma_f32_32x32x16_bf16 v[168:183], v[232:235], v[108:111], v[168:183]
    ds_read_b64_tr_b16 v[248:249], v18 offset:55296
    ds_read_b64_tr_b16 v[250:251], v18 offset:55808
    v_mfma_f32_32x32x16_bf16 v[184:199], v[236:239], v[108:111], v[184:199]
    ds_read_b64_tr_b16 v[252:253], v19 offset:55296
    ds_read_b64_tr_b16 v[254:255], v19 offset:55808
    s_add_u32 m0, s71, 18432
    s_xor_b32 s65, s69, 7
    s_mul_i32 s65, s65, 229376
    s_add_u32 s25, s65, s70
    buffer_load_dwordx4 v160, s[12:15], s25 offen lds
    s_waitcnt vmcnt(5)
    s_barrier
    s_waitcnt lgkmcnt(4)
    v_mfma_f32_32x32x16_bf16 v[168:183], v[240:243], v[112:115], v[168:183]
    ds_read_b64_tr_b16 v[232:233], v16 offset:16384
    ds_read_b64_tr_b16 v[234:235], v16 offset:16896
    buffer_load_dwordx4 v161, s[12:15], s25 offen offset:1024 lds
    v_mfma_f32_32x32x16_bf16 v[184:199], v[244:247], v[112:115], v[184:199]
    ds_read_b64_tr_b16 v[236:237], v17 offset:16384
    ds_read_b64_tr_b16 v[238:239], v17 offset:16896
    ds_read_b128 v[120:123], v152 offset:0
    ds_read_b128 v[124:127], v153 offset:0
    s_waitcnt lgkmcnt(6)
    v_mfma_f32_32x32x16_bf16 v[168:183], v[248:251], v[116:119], v[168:183]
    ds_read_b64_tr_b16 v[240:241], v18 offset:16384
    ds_read_b64_tr_b16 v[242:243], v18 offset:16896
    ds_read_b128 v[128:131], v154 offset:0
    ds_read_b128 v[132:135], v155 offset:0
    v_mfma_f32_32x32x16_bf16 v[184:199], v[252:255], v[116:119], v[184:199]
    ds_read_b64_tr_b16 v[244:245], v19 offset:16384
    ds_read_b64_tr_b16 v[246:247], v19 offset:16896
    s_add_u32 m0, s71, 8192
    s_add_u32 s18, s18, 128
    buffer_load_dwordx4 v160, s[12:15], s18 offen lds
    s_waitcnt lgkmcnt(2)
    v_mfma_f32_32x32x16_bf16 v[168:183], v[232:235], v[120:123], v[168:183]
    ds_read_b64_tr_b16 v[248:249], v16 offset:57344
    ds_read_b64_tr_b16 v[250:251], v16 offset:57856
    buffer_load_dwordx4 v161, s[12:15], s18 offen offset:1024 lds
    v_mfma_f32_32x32x16_bf16 v[184:199], v[236:239], v[120:123], v[184:199]
    ds_read_b64_tr_b16 v[252:253], v17 offset:57344
    ds_read_b64_tr_b16 v[254:255], v17 offset:57856
    s_add_u32 m0, s71, 10240
    s_add_u32 s19, s19, 128
    buffer_load_dwordx4 v160, s[12:15], s19 offen lds
    s_waitcnt lgkmcnt(4)
    v_mfma_f32_32x32x16_bf16 v[168:183], v[240:243], v[124:127], v[168:183]
    ds_read_b64_tr_b16 v[232:233], v18 offset:57344
    ds_read_b64_tr_b16 v[234:235], v18 offset:57856
    buffer_load_dwordx4 v161, s[12:15], s19 offen offset:1024 lds
    v_mfma_f32_32x32x16_bf16 v[184:199], v[244:247], v[124:127], v[184:199]
    ds_read_b64_tr_b16 v[236:237], v19 offset:57344
    ds_read_b64_tr_b16 v[238:239], v19 offset:57856
    s_waitcnt vmcnt(4)
    s_barrier
    s_waitcnt lgkmcnt(4)
    v_mfma_f32_32x32x16_bf16 v[168:183], v[248:251], v[128:131], v[168:183]
    ds_read_b64_tr_b16 v[240:241], v16 offset:18432
    ds_read_b64_tr_b16 v[242:243], v16 offset:18944
    s_add_u32 m0, s71, 12288
    s_add_u32 s20, s20, 128
    buffer_load_dwordx4 v160, s[12:15], s20 offen lds
    v_mfma_f32_32x32x16_bf16 v[184:199], v[252:255], v[128:131], v[184:199]
    ds_read_b64_tr_b16 v[244:245], v17 offset:18432
    ds_read_b64_tr_b16 v[246:247], v17 offset:18944
    buffer_load_dwordx4 v161, s[12:15], s20 offen offset:1024 lds
    s_waitcnt lgkmcnt(4)
    v_mfma_f32_32x32x16_bf16 v[168:183], v[232:235], v[132:135], v[168:183]
    ds_read_b64_tr_b16 v[248:249], v18 offset:18432
    ds_read_b64_tr_b16 v[250:251], v18 offset:18944
    ds_read_b128 v[136:139], v152 offset:4096
    ds_read_b128 v[140:143], v153 offset:4096
    v_mfma_f32_32x32x16_bf16 v[184:199], v[236:239], v[132:135], v[184:199]
    ds_read_b64_tr_b16 v[252:253], v19 offset:18432
    ds_read_b64_tr_b16 v[254:255], v19 offset:18944
    ds_read_b128 v[144:147], v154 offset:4096
    ds_read_b128 v[148:151], v155 offset:4096
    s_waitcnt lgkmcnt(0)
    v_mfma_f32_32x32x16_bf16 v[168:183], v[240:243], v[136:139], v[168:183]
    ds_read_b64_tr_b16 v[232:233], v16 offset:59392
    ds_read_b64_tr_b16 v[234:235], v16 offset:59904
    s_add_u32 m0, s71, 0
    s_add_u32 s21, s21, 128
    buffer_load_dwordx4 v160, s[12:15], s21 offen lds
    v_mfma_f32_32x32x16_bf16 v[184:199], v[244:247], v[136:139], v[184:199]
    ds_read_b64_tr_b16 v[236:237], v17 offset:59392
    ds_read_b64_tr_b16 v[238:239], v17 offset:59904
    buffer_load_dwordx4 v161, s[12:15], s21 offen offset:1024 lds
    v_mfma_f32_32x32x16_bf16 v[168:183], v[248:251], v[140:143], v[168:183]
    ds_read_b64_tr_b16 v[240:241], v18 offset:59392
    ds_read_b64_tr_b16 v[242:243], v18 offset:59904
    s_add_u32 m0, s71, 2048
    s_add_u32 s22, s22, 128
    buffer_load_dwordx4 v160, s[12:15], s22 offen lds
    v_lshrrev_b32 v6, 5, v1
    v_lshlrev_b32 v6, 9, v6
    v_bfe_u32 v7, v1, 2, 2
    v_lshl_add_u32 v6, v7, 7, v6
    v_and_b32 v7, 1, v1
    v_lshl_add_u32 v6, v7, 6, v6
    v_bfe_u32 v7, v1, 4, 1
    v_lshl_add_u32 v6, v7, 4, v6
    v_bfe_u32 v7, v1, 1, 1
    v_lshl_add_u32 v6, v7, 3, v6
    v_mfma_f32_32x32x16_bf16 v[184:199], v[252:255], v[140:143], v[184:199]
    ds_read_b64_tr_b16 v[244:245], v19 offset:59392
    ds_read_b64_tr_b16 v[246:247], v19 offset:59904
    buffer_load_dwordx4 v161, s[12:15], s22 offen offset:1024 lds
    v_bfe_u32 v7, v1, 3, 1
    v_xor_b32 v7, s67, v7
    v_lshl_add_u32 v6, v7, 5, v6
    v_add_u32 v152, s71, v6
    v_xor_b32 v153, 32, v152
    v_min_u32 v7, 27, v1
    v_lshrrev_b32 v6, 1, v7
    v_mul_u32_u24 v154, 37, v6
    v_lshrrev_b32 v154, 8, v154
    v_mul_u32_u24 v155, 7, v154
    s_waitcnt vmcnt(8)
    s_barrier
    s_waitcnt lgkmcnt(4)
    v_mfma_f32_32x32x16_bf16 v[168:183], v[232:235], v[144:147], v[168:183]
    ds_read_b64_tr_b16 v[248:249], v16 offset:8192
    ds_read_b64_tr_b16 v[250:251], v16 offset:8704
    v_sub_u32 v6, v6, v155
    s_lshr_b32 s28, s78, 1
    s_and_b32 s29, s28, 3
    s_mul_i32 s29, s29, 7
    v_add_u32 v6, s29, v6
    s_lshr_b32 s28, s28, 2
    s_lshl_b32 s28, s28, 1
    v_add_u32 v154, s28, v154
    v_lshl_add_u32 v6, v6, 3, v154
    s_and_b32 s28, s78, 1
    v_mfma_f32_32x32x16_bf16 v[184:199], v[236:239], v[144:147], v[184:199]
    ds_read_b64_tr_b16 v[252:253], v17 offset:8192
    ds_read_b64_tr_b16 v[254:255], v17 offset:8704
    s_add_u32 m0, s71, 14336
    s_add_u32 s23, s23, 128
    buffer_load_dwordx4 v160, s[12:15], s23 offen lds
    s_lshl_b32 s28, s28, 1
    v_and_b32 v7, 1, v7
    v_add_u32 v7, s28, v7
    v_lshl_add_u32 v6, v6, 2, v7
    v_lshlrev_b32 v154, 6, v6
    s_mul_i32 s30, s78, 229376
    s_lshl_b32 s28, s3, 10
    s_add_u32 s30, s30, s28
    s_add_u32 s30, s30, 5242880
    s_mul_i32 s31, s66, 114688
    s_waitcnt lgkmcnt(4)
    v_mfma_f32_32x32x16_bf16 v[168:183], v[240:243], v[148:151], v[168:183]
    ds_read_b64_tr_b16 v[232:233], v18 offset:8192
    ds_read_b64_tr_b16 v[234:235], v18 offset:8704
    buffer_load_dwordx4 v161, s[12:15], s23 offen offset:1024 lds
    s_sub_u32 s32, 114688, s31
    v_mfma_f32_32x32x16_bf16 v[184:199], v[244:247], v[148:151], v[184:199]
    ds_read_b64_tr_b16 v[236:237], v19 offset:8192
    ds_read_b64_tr_b16 v[238:239], v19 offset:8704
    buffer_load_dwordx4 v[164:167], v23, s[4:7], s72 offen sc1
    buffer_load_dwordx4 v[8:11], v22, s[4:7], s76 offen offset:0 sc1
    buffer_load_dwordx4 v[12:15], v22, s[4:7], s76 offen offset:1024 sc1
    s_waitcnt lgkmcnt(4)
    v_mfma_f32_32x32x16_bf16 v[200:215], v[248:251], v[24:27], 0
    ds_read_b64_tr_b16 v[240:241], v16 offset:49152
    ds_read_b64_tr_b16 v[242:243], v16 offset:49664
    s_add_u32 m0, s71, 16384
    s_add_u32 s24, s24, 128
    buffer_load_dwordx4 v160, s[12:15], s24 offen lds
    v_mfma_f32_32x32x16_bf16 v[216:231], v[252:255], v[24:27], 0
    ds_read_b64_tr_b16 v[244:245], v17 offset:49152
    ds_read_b64_tr_b16 v[246:247], v17 offset:49664
    buffer_load_dwordx4 v161, s[12:15], s24 offen offset:1024 lds
    s_waitcnt lgkmcnt(4)
    v_mfma_f32_32x32x16_bf16 v[200:215], v[232:235], v[28:31], v[200:215]
    ds_read_b64_tr_b16 v[248:249], v18 offset:49152
    ds_read_b64_tr_b16 v[250:251], v18 offset:49664
    s_add_u32 m0, s71, 4096
    s_add_u32 s25, s25, 128
    buffer_load_dwordx4 v160, s[12:15], s25 offen lds
    v_mfma_f32_32x32x16_bf16 v[216:231], v[236:239], v[28:31], v[216:231]
    ds_read_b64_tr_b16 v[252:253], v19 offset:49152
    ds_read_b64_tr_b16 v[254:255], v19 offset:49664
    buffer_load_dwordx4 v161, s[12:15], s25 offen offset:1024 lds
    s_waitcnt vmcnt(15)
    s_barrier
    s_waitcnt lgkmcnt(4)
    v_mfma_f32_32x32x16_bf16 v[200:215], v[240:243], v[32:35], v[200:215]
    ds_read_b64_tr_b16 v[232:233], v16 offset:10240
    ds_read_b64_tr_b16 v[234:235], v16 offset:10752
    s_add_u32 m0, s71, 6144
    s_add_u32 s35, s73, 1572864
    buffer_load_dwordx4 v20, s[52:55], s35 offen lds
    v_mfma_f32_32x32x16_bf16 v[216:231], v[244:247], v[32:35], v[216:231]
    ds_read_b64_tr_b16 v[236:237], v17 offset:10240
    ds_read_b64_tr_b16 v[238:239], v17 offset:10752
    buffer_load_dwordx4 v21, s[52:55], s35 offen offset:1024 lds
    s_waitcnt lgkmcnt(4)
    v_mfma_f32_32x32x16_bf16 v[200:215], v[248:251], v[36:39], v[200:215]
    ds_read_b64_tr_b16 v[240:241], v18 offset:10240
    ds_read_b64_tr_b16 v[242:243], v18 offset:10752
    s_add_u32 m0, s71, 18432
    s_add_u32 s35, s73, 1703936
    buffer_load_dwordx4 v20, s[52:55], s35 offen lds
    v_mfma_f32_32x32x16_bf16 v[216:231], v[252:255], v[36:39], v[216:231]
    ds_read_b64_tr_b16 v[244:245], v19 offset:10240
    ds_read_b64_tr_b16 v[246:247], v19 offset:10752
    buffer_load_dwordx4 v21, s[52:55], s35 offen offset:1024 lds
    s_waitcnt lgkmcnt(4)
    v_mfma_f32_32x32x16_bf16 v[200:215], v[232:235], v[40:43], v[200:215]
    ds_read_b64_tr_b16 v[248:249], v16 offset:51200
    ds_read_b64_tr_b16 v[250:251], v16 offset:51712
    s_mov_b32 s69, 0
L_a_cfpoll0:
    s_waitcnt vmcnt(8)
    v_xor_b32 v4, s50, v11
    v_xor_b32 v5, s50, v15
    v_xor_b32 v6, s50, v167
    v_or3_b32 v4, v4, v5, v6
    v_cmp_ne_u32 vcc, 0, v4
    s_add_u32 s69, s69, 1
    s_cmp_eq_u64 vcc, 0
    s_cbranch_scc1 L_a_cfok0
    s_cmp_ge_u32 s69, 200000
    s_cbranch_scc1 L_a_cfok0
    s_sleep 1
    buffer_load_dwordx4 v[164:167], v23, s[4:7], s72 offen sc1
    buffer_load_dwordx4 v[8:11], v22, s[4:7], s76 offen offset:0 sc1
    buffer_load_dwordx4 v[12:15], v22, s[4:7], s76 offen offset:1024 sc1
    s_waitcnt vmcnt(0)
    s_branch L_a_cfpoll0
L_a_cfok0:
    v_mov_b32 v11, 0
    v_mov_b32 v15, 0
    v_and_b32 v158, 0xffff0000, v165
    v_lshlrev_b32 v4, 16, v166
    v_add_f32 v158, v158, v4
    v_rcp_f32 v4, v158
    v_mov_b32 v167, 0
    v_mul_f32 v156, 0xc0135761, v4
    v_mul_f32 v5, v4, v4
    v_mul_f32 v5, v5, v4
    v_mul_f32 v157, 0xbdd2d3e8, v5
    s_lshl_b32 s72, s63, 2
    s_add_u32 s72, s72, s3
    s_mul_i32 s72, s72, 114688
    s_lshl_b32 s65, s64, 13
    s_add_u32 s72, s72, s65
    s_add_u32 s72, s72, 5242880
    v_mfma_f32_32x32x16_bf16 v[168:183], v[8:11], v[164:167], v[168:183]
    v_mfma_f32_32x32x16_bf16 v[184:199], v[12:15], v[164:167], v[184:199]
    buffer_load_dwordx4 v[8:11], v22, s[4:7], s76 offen offset:2048 sc1
    buffer_load_dwordx4 v[12:15], v22, s[4:7], s76 offen offset:3072 sc1
    s_nop 8
    v_mul_f32 v24, v168, v168
    v_mul_f32 v25, v169, v169
    v_mul_f32 v26, v170, v170
    v_mul_f32 v27, v171, v171
    v_fma_f32 v24, v24, v157, v156
    v_fma_f32 v25, v25, v157, v156
    v_mfma_f32_32x32x16_bf16 v[216:231], v[236:239], v[40:43], v[216:231]
    ds_read_b64_tr_b16 v[252:253], v17 offset:51200
    ds_read_b64_tr_b16 v[254:255], v17 offset:51712
    v_fma_f32 v26, v26, v157, v156
    v_fma_f32 v27, v27, v157, v156
    v_mul_f32 v24, v24, v168
    v_mul_f32 v25, v25, v169
    v_mul_f32 v26, v26, v170
    v_mul_f32 v27, v27, v171
    v_exp_f32 v24, v24
    v_exp_f32 v25, v25
    v_exp_f32 v26, v26
    v_exp_f32 v27, v27
    v_fma_f32 v24, v24, v158, v158
    v_fma_f32 v25, v25, v158, v158
    s_waitcnt lgkmcnt(4)
    v_mfma_f32_32x32x16_bf16 v[200:215], v[240:243], v[44:47], v[200:215]
    ds_read_b64_tr_b16 v[232:233], v18 offset:51200
    ds_read_b64_tr_b16 v[234:235], v18 offset:51712
    v_fma_f32 v26, v26, v158, v158
    v_fma_f32 v27, v27, v158, v158
    v_rcp_f32 v24, v24
    v_rcp_f32 v25, v25
    v_rcp_f32 v26, v26
    v_rcp_f32 v27, v27
    v_mul_f32 v24, v24, v168
    v_mul_f32 v25, v25, v169
    v_mul_f32 v26, v26, v170
    v_mul_f32 v27, v27, v171
    v_cvt_pk_bf16_f32 v32, v24, v25
    v_cvt_pk_bf16_f32 v33, v26, v27
    v_mfma_f32_32x32x16_bf16 v[216:231], v[244:247], v[44:47], v[216:231]
    ds_read_b64_tr_b16 v[236:237], v19 offset:51200
    ds_read_b64_tr_b16 v[238:239], v19 offset:51712
    v_mul_f32 v28, v172, v172
    v_mul_f32 v29, v173, v173
    v_mul_f32 v30, v174, v174
    v_mul_f32 v31, v175, v175
    v_fma_f32 v28, v28, v157, v156
    v_fma_f32 v29, v29, v157, v156
    v_fma_f32 v30, v30, v157, v156
    v_fma_f32 v31, v31, v157, v156
    v_mul_f32 v28, v28, v172
    v_mul_f32 v29, v29, v173
    v_mul_f32 v30, v30, v174
    v_mul_f32 v31, v31, v175
    s_barrier
    s_waitcnt lgkmcnt(4)
    v_mfma_f32_32x32x16_bf16 v[200:215], v[248:251], v[48:51], v[200:215]
    ds_read_b64_tr_b16 v[240:241], v16 offset:12288
    ds_read_b64_tr_b16 v[242:243], v16 offset:12800
    s_add_u32 m0, s71, 8192
    s_add_u32 s35, s73, 65536
    buffer_load_dwordx4 v20, s[52:55], s35 offen lds
    v_exp_f32 v28, v28
    v_exp_f32 v29, v29
    v_exp_f32 v30, v30
    v_exp_f32 v31, v31
    v_fma_f32 v28, v28, v158, v158
    v_fma_f32 v29, v29, v158, v158
    v_fma_f32 v30, v30, v158, v158
    v_fma_f32 v31, v31, v158, v158
    v_rcp_f32 v28, v28
    v_rcp_f32 v29, v29
    v_mfma_f32_32x32x16_bf16 v[216:231], v[252:255], v[48:51], v[216:231]
    ds_read_b64_tr_b16 v[244:245], v17 offset:12288
    ds_read_b64_tr_b16 v[246:247], v17 offset:12800
    buffer_load_dwordx4 v21, s[52:55], s35 offen offset:1024 lds
    v_rcp_f32 v30, v30
    v_rcp_f32 v31, v31
    v_mul_f32 v28, v28, v172
    v_mul_f32 v29, v29, v173
    v_mul_f32 v30, v30, v174
    v_mul_f32 v31, v31, v175
    v_cvt_pk_bf16_f32 v34, v28, v29
    v_cvt_pk_bf16_f32 v35, v30, v31
    buffer_store_dwordx4 v[32:35], v22, s[4:7], s72 offen offset:0 sc1
    v_mul_f32 v24, v176, v176
    s_waitcnt lgkmcnt(4)
    v_mfma_f32_32x32x16_bf16 v[200:215], v[232:235], v[52:55], v[200:215]
    ds_read_b64_tr_b16 v[248:249], v18 offset:12288
    ds_read_b64_tr_b16 v[250:251], v18 offset:12800
    v_mul_f32 v25, v177, v177
    v_mul_f32 v26, v178, v178
    v_mul_f32 v27, v179, v179
    v_fma_f32 v24, v24, v157, v156
    v_fma_f32 v25, v25, v157, v156
    v_fma_f32 v26, v26, v157, v156
    v_fma_f32 v27, v27, v157, v156
    v_mul_f32 v24, v24, v176
    v_mul_f32 v25, v25, v177
    v_mul_f32 v26, v26, v178
    v_mul_f32 v27, v27, v179
    v_exp_f32 v24, v24
    v_mfma_f32_32x32x16_bf16 v[216:231], v[236:239], v[52:55], v[216:231]
    ds_read_b64_tr_b16 v[252:253], v19 offset:12288
    ds_read_b64_tr_b16 v[254:255], v19 offset:12800
    v_exp_f32 v25, v25
    v_exp_f32 v26, v26
    v_exp_f32 v27, v27
    v_fma_f32 v24, v24, v158, v158
    v_fma_f32 v25, v25, v158, v158
    v_fma_f32 v26, v26, v158, v158
    v_fma_f32 v27, v27, v158, v158
    v_rcp_f32 v24, v24
    v_rcp_f32 v25, v25
    v_rcp_f32 v26, v26
    v_rcp_f32 v27, v27
    v_mul_f32 v24, v24, v176
    s_waitcnt lgkmcnt(4)
    v_mfma_f32_32x32x16_bf16 v[200:215], v[240:243], v[56:59], v[200:215]
    ds_read_b64_tr_b16 v[232:233], v16 offset:53248
    ds_read_b64_tr_b16 v[234:235], v16 offset:53760
    s_add_u32 s37, s73, 0
    buffer_load_dwordx4 v[40:43], v20, s[52:55], s37 offen
    v_mul_f32 v25, v25, v177
    v_mul_f32 v26, v26, v178
    v_mul_f32 v27, v27, v179
    v_cvt_pk_bf16_f32 v36, v24, v25
    v_cvt_pk_bf16_f32 v37, v26, v27
    v_mul_f32 v28, v180, v180
    v_mul_f32 v29, v181, v181
    v_mul_f32 v30, v182, v182
    v_mul_f32 v31, v183, v183
    v_fma_f32 v28, v28, v157, v156
    v_mfma_f32_32x32x16_bf16 v[216:231], v[244:247], v[56:59], v[216:231]
    ds_read_b64_tr_b16 v[236:237], v17 offset:53248
    ds_read_b64_tr_b16 v[238:239], v17 offset:53760
    buffer_load_dwordx4 v[44:47], v21, s[52:55], s37 offen offset:1024
    v_fma_f32 v29, v29, v157, v156
    v_fma_f32 v30, v30, v157, v156
    v_fma_f32 v31, v31, v157, v156
    v_mul_f32 v28, v28, v180
    v_mul_f32 v29, v29, v181
    v_mul_f32 v30, v30, v182
    v_mul_f32 v31, v31, v183
    v_exp_f32 v28, v28
    v_exp_f32 v29, v29
    v_exp_f32 v30, v30
    s_waitcnt lgkmcnt(4)
    v_mfma_f32_32x32x16_bf16 v[200:215], v[248:251], v[60:63], v[200:215]
    ds_read_b64_tr_b16 v[240:241], v18 offset:53248
    ds_read_b64_tr_b16 v[242:243], v18 offset:53760
    s_add_u32 s37, s73, 131072
    buffer_load_dwordx4 v[48:51], v20, s[52:55], s37 offen
    v_exp_f32 v31, v31
    v_fma_f32 v28, v28, v158, v158
    v_fma_f32 v29, v29, v158, v158
    v_fma_f32 v30, v30, v158, v158
    v_fma_f32 v31, v31, v158, v158
    v_rcp_f32 v28, v28
    v_rcp_f32 v29, v29
    v_rcp_f32 v30, v30
    v_rcp_f32 v31, v31
    v_mul_f32 v28, v28, v180
    v_mfma_f32_32x32x16_bf16 v[216:231], v[252:255], v[60:63], v[216:231]
    ds_read_b64_tr_b16 v[244:245], v19 offset:53248
    ds_read_b64_tr_b16 v[246:247], v19 offset:53760
    buffer_load_dwordx4 v[52:55], v21, s[52:55], s37 offen offset:1024
    v_mul_f32 v29, v29, v181
    v_mul_f32 v30, v30, v182
    v_mul_f32 v31, v31, v183
    v_cvt_pk_bf16_f32 v38, v28, v29
    v_cvt_pk_bf16_f32 v39, v30, v31
    buffer_store_dwordx4 v[36:39], v22, s[4:7], s72 offen offset:1024 sc1
    v_mul_f32 v24, v184, v184
    v_mul_f32 v25, v185, v185
    v_mul_f32 v26, v186, v186
    v_mul_f32 v27, v187, v187
    s_barrier
    s_waitcnt lgkmcnt(4)
    v_mfma_f32_32x32x16_bf16 v[200:215], v[232:235], v[64:67], v[200:215]
    ds_read_b64_tr_b16 v[248:249], v16 offset:0
    ds_read_b64_tr_b16 v[250:251], v16 offset:512
    s_add_u32 m0, s71, 10240
    s_add_u32 s35, s73, 196608
    buffer_load_dwordx4 v20, s[52:55], s35 offen lds
    v_fma_f32 v24, v24, v157, v156
    v_fma_f32 v25, v25, v157, v156
    v_fma_f32 v26, v26, v157, v156
    v_fma_f32 v27, v27, v157, v156
    v_mul_f32 v24, v24, v184
    v_mul_f32 v25, v25, v185
    v_mul_f32 v26, v26, v186
    v_mul_f32 v27, v27, v187
    v_exp_f32 v24, v24
    v_exp_f32 v25, v25
    v_mfma_f32_32x32x16_bf16 v[216:231], v[236:239], v[64:67], v[216:231]
    ds_read_b64_tr_b16 v[252:253], v17 offset:0
    ds_read_b64_tr_b16 v[254:255], v17 offset:512
    buffer_load_dwordx4 v21, s[52:55], s35 offen offset:1024 lds
    v_exp_f32 v26, v26
    v_exp_f32 v27, v27
    v_fma_f32 v24, v24, v158, v158
    v_fma_f32 v25, v25, v158, v158
    v_fma_f32 v26, v26, v158, v158
    v_fma_f32 v27, v27, v158, v158
    v_rcp_f32 v24, v24
    v_rcp_f32 v25, v25
    v_rcp_f32 v26, v26
    v_rcp_f32 v27, v27
    s_waitcnt lgkmcnt(4)
    v_mfma_f32_32x32x16_bf16 v[200:215], v[240:243], v[68:71], v[200:215]
    ds_read_b64_tr_b16 v[232:233], v18 offset:0
    ds_read_b64_tr_b16 v[234:235], v18 offset:512
    v_mul_f32 v24, v24, v184
    v_mul_f32 v25, v25, v185
    v_mul_f32 v26, v26, v186
    v_mul_f32 v27, v27, v187
    v_cvt_pk_bf16_f32 v32, v24, v25
    v_cvt_pk_bf16_f32 v33, v26, v27
    v_mul_f32 v28, v188, v188
    v_mul_f32 v29, v189, v189
    v_mul_f32 v30, v190, v190
    v_mul_f32 v31, v191, v191
    v_fma_f32 v28, v28, v157, v156
    v_fma_f32 v29, v29, v157, v156
    v_mfma_f32_32x32x16_bf16 v[216:231], v[244:247], v[68:71], v[216:231]
    ds_read_b64_tr_b16 v[236:237], v19 offset:0
    ds_read_b64_tr_b16 v[238:239], v19 offset:512
    v_fma_f32 v30, v30, v157, v156
    v_fma_f32 v31, v31, v157, v156
    v_mul_f32 v28, v28, v188
    v_mul_f32 v29, v29, v189
    v_mul_f32 v30, v30, v190
    v_mul_f32 v31, v31, v191
    v_exp_f32 v28, v28
    v_exp_f32 v29, v29
    v_exp_f32 v30, v30
    v_exp_f32 v31, v31
    v_fma_f32 v28, v28, v158, v158
    v_fma_f32 v29, v29, v158, v158
    s_waitcnt lgkmcnt(4)
    v_mfma_f32_32x32x16_bf16 v[200:215], v[248:251], v[72:75], v[200:215]
    ds_read_b64_tr_b16 v[240:241], v16 offset:40960
    ds_read_b64_tr_b16 v[242:243], v16 offset:41472
    s_add_u32 s37, s73, 262144
    buffer_load_dwordx4 v[56:59], v20, s[52:55], s37 offen
    v_fma_f32 v30, v30, v158, v158
    v_fma_f32 v31, v31, v158, v158
    v_rcp_f32 v28, v28
    v_rcp_f32 v29, v29
    v_rcp_f32 v30, v30
    v_rcp_f32 v31, v31
    v_mul_f32 v28, v28, v188
    v_mul_f32 v29, v29, v189
    v_mul_f32 v30, v30, v190
    v_mul_f32 v31, v31, v191
    v_mfma_f32_32x32x16_bf16 v[216:231], v[252:255], v[72:75], v[216:231]
    ds_read_b64_tr_b16 v[244:245], v17 offset:40960
    ds_read_b64_tr_b16 v[246:247], v17 offset:41472
    buffer_load_dwordx4 v[60:63], v21, s[52:55], s37 offen offset:1024
    v_cvt_pk_bf16_f32 v34, v28, v29
    v_cvt_pk_bf16_f32 v35, v30, v31
    buffer_store_dwordx4 v[32:35], v22, s[4:7], s72 offen offset:2048 sc1
    v_mul_f32 v24, v192, v192
    v_mul_f32 v25, v193, v193
    v_mul_f32 v26, v194, v194
    v_mul_f32 v27, v195, v195
    v_fma_f32 v24, v24, v157, v156
    v_fma_f32 v25, v25, v157, v156
    v_fma_f32 v26, v26, v157, v156
    s_waitcnt lgkmcnt(4)
    v_mfma_f32_32x32x16_bf16 v[200:215], v[232:235], v[76:79], v[200:215]
    ds_read_b64_tr_b16 v[248:249], v18 offset:40960
    ds_read_b64_tr_b16 v[250:251], v18 offset:41472
    s_add_u32 s37, s73, 393216
    buffer_load_dwordx4 v[64:67], v20, s[52:55], s37 offen
    v_fma_f32 v27, v27, v157, v156
    v_mul_f32 v24, v24, v192
    v_mul_f32 v25, v25, v193
    v_mul_f32 v26, v26, v194
    v_mul_f32 v27, v27, v195
    v_exp_f32 v24, v24
    v_exp_f32 v25, v25
    v_exp_f32 v26, v26
    v_exp_f32 v27, v27
    v_fma_f32 v24, v24, v158, v158
    v_mfma_f32_32x32x16_bf16 v[216:231], v[236:239], v[76:79], v[216:231]
    ds_read_b64_tr_b16 v[252:253], v19 offset:40960
    ds_read_b64_tr_b16 v[254:255], v19 offset:41472
    buffer_load_dwordx4 v[68:71], v21, s[52:55], s37 offen offset:1024
    v_fma_f32 v25, v25, v158, v158
    v_fma_f32 v26, v26, v158, v158
    v_fma_f32 v27, v27, v158, v158
    v_rcp_f32 v24, v24
    v_rcp_f32 v25, v25
    v_rcp_f32 v26, v26
    v_rcp_f32 v27, v27
    v_mul_f32 v24, v24, v192
    v_mul_f32 v25, v25, v193
    v_mul_f32 v26, v26, v194
    s_barrier
    s_waitcnt lgkmcnt(4)
    v_mfma_f32_32x32x16_bf16 v[200:215], v[240:243], v[80:83], v[200:215]
    ds_read_b64_tr_b16 v[232:233], v16 offset:2048
    ds_read_b64_tr_b16 v[234:235], v16 offset:2560
    s_add_u32 m0, s71, 12288
    s_add_u32 s35, s73, 327680
    buffer_load_dwordx4 v20, s[52:55], s35 offen lds
    v_mul_f32 v27, v27, v195
    v_cvt_pk_bf16_f32 v36, v24, v25
    v_cvt_pk_bf16_f32 v37, v26, v27
    v_mul_f32 v28, v196, v196
    v_mul_f32 v29, v197, v197
    v_mul_f32 v30, v198, v198
    v_mul_f32 v31, v199, v199
    v_fma_f32 v28, v28, v157, v156
    v_fma_f32 v29, v29, v157, v156
    v_fma_f32 v30, v30, v157, v156
    v_mfma_f32_32x32x16_bf16 v[216:231], v[244:247], v[80:83], v[216:231]
    ds_read_b64_tr_b16 v[236:237], v17 offset:2048
    ds_read_b64_tr_b16 v[238:239], v17 offset:2560
    buffer_load_dwordx4 v21, s[52:55], s35 offen offset:1024 lds
    v_fma_f32 v31, v31, v157, v156
    v_mul_f32 v28, v28, v196
    v_mul_f32 v29, v29, v197
    v_mul_f32 v30, v30, v198
    v_mul_f32 v31, v31, v199
    v_exp_f32 v28, v28
    v_exp_f32 v29, v29
    v_exp_f32 v30, v30
    v_exp_f32 v31, v31
    v_fma_f32 v28, v28, v158, v158
    s_waitcnt lgkmcnt(4)
    v_mfma_f32_32x32x16_bf16 v[200:215], v[248:251], v[84:87], v[200:215]
    ds_read_b64_tr_b16 v[240:241], v18 offset:2048
    ds_read_b64_tr_b16 v[242:243], v18 offset:2560
    v_fma_f32 v29, v29, v158, v158
    v_fma_f32 v30, v30, v158, v158
    v_fma_f32 v31, v31, v158, v158
    v_rcp_f32 v28, v28
    v_rcp_f32 v29, v29
    v_rcp_f32 v30, v30
    v_rcp_f32 v31, v31
    v_mul_f32 v28, v28, v196
    v_mul_f32 v29, v29, v197
    v_mul_f32 v30, v30, v198
    v_mul_f32 v31, v31, v199
    v_cvt_pk_bf16_f32 v38, v28, v29
    v_mfma_f32_32x32x16_bf16 v[216:231], v[252:255], v[84:87], v[216:231]
    ds_read_b64_tr_b16 v[244:245], v19 offset:2048
    ds_read_b64_tr_b16 v[246:247], v19 offset:2560
    v_cvt_pk_bf16_f32 v39, v30, v31
    buffer_store_dwordx4 v[36:39], v22, s[4:7], s72 offen offset:3072 sc1
    s_waitcnt lgkmcnt(4)
    v_mfma_f32_32x32x16_bf16 v[200:215], v[232:235], v[88:91], v[200:215]
    ds_read_b64_tr_b16 v[248:249], v16 offset:43008
    ds_read_b64_tr_b16 v[250:251], v16 offset:43520
    s_add_u32 s37, s73, 524288
    buffer_load_dwordx4 v[72:75], v20, s[52:55], s37 offen
    v_mfma_f32_32x32x16_bf16 v[216:231], v[236:239], v[88:91], v[216:231]
    ds_read_b64_tr_b16 v[252:253], v17 offset:43008
    ds_read_b64_tr_b16 v[254:255], v17 offset:43520
    buffer_load_dwordx4 v[76:79], v21, s[52:55], s37 offen offset:1024
    s_waitcnt lgkmcnt(4)
    v_mfma_f32_32x32x16_bf16 v[200:215], v[240:243], v[92:95], v[200:215]
    ds_read_b64_tr_b16 v[232:233], v18 offset:43008
    ds_read_b64_tr_b16 v[234:235], v18 offset:43520
    s_add_u32 s37, s73, 655360
    buffer_load_dwordx4 v[80:83], v20, s[52:55], s37 offen
    v_mfma_f32_32x32x16_bf16 v[216:231], v[244:247], v[92:95], v[216:231]
    ds_read_b64_tr_b16 v[236:237], v19 offset:43008
    ds_read_b64_tr_b16 v[238:239], v19 offset:43520
    buffer_load_dwordx4 v[84:87], v21, s[52:55], s37 offen offset:1024
    s_barrier
    s_waitcnt lgkmcnt(4)
    v_mfma_f32_32x32x16_bf16 v[200:215], v[248:251], v[96:99], v[200:215]
    ds_read_b64_tr_b16 v[240:241], v16 offset:14336
    ds_read_b64_tr_b16 v[242:243], v16 offset:14848
    s_add_u32 m0, s71, 0
    s_add_u32 s35, s73, 458752
    buffer_load_dwordx4 v20, s[52:55], s35 offen lds
    v_mfma_f32_32x32x16_bf16 v[216:231], v[252:255], v[96:99], v[216:231]
    ds_read_b64_tr_b16 v[244:245], v17 offset:14336
    ds_read_b64_tr_b16 v[246:247], v17 offset:14848
    buffer_load_dwordx4 v21, s[52:55], s35 offen offset:1024 lds
    s_waitcnt lgkmcnt(4)
    v_mfma_f32_32x32x16_bf16 v[200:215], v[232:235], v[100:103], v[200:215]
    ds_read_b64_tr_b16 v[248:249], v18 offset:14336
    ds_read_b64_tr_b16 v[250:251], v18 offset:14848
    v_mfma_f32_32x32x16_bf16 v[216:231], v[236:239], v[100:103], v[216:231]
    ds_read_b64_tr_b16 v[252:253], v19 offset:14336
    ds_read_b64_tr_b16 v[254:255], v19 offset:14848
    s_waitcnt lgkmcnt(4)
    v_mfma_f32_32x32x16_bf16 v[200:215], v[240:243], v[104:107], v[200:215]
    ds_read_b64_tr_b16 v[232:233], v16 offset:55296
    ds_read_b64_tr_b16 v[234:235], v16 offset:55808
    s_add_u32 s37, s73, 786432
    buffer_load_dwordx4 v[88:91], v20, s[52:55], s37 offen
    v_mfma_f32_32x32x16_bf16 v[216:231], v[244:247], v[104:107], v[216:231]
    ds_read_b64_tr_b16 v[236:237], v17 offset:55296
    ds_read_b64_tr_b16 v[238:239], v17 offset:55808
    buffer_load_dwordx4 v[92:95], v21, s[52:55], s37 offen offset:1024
    s_waitcnt vmcnt(8)
    v_mov_b32 v24, s50
    v_mov_b32 v25, s51
    s_lshl_b32 s65, s60, 2
    s_add_u32 s65, s65, s3
    s_lshl_b32 s65, s65, 6
    s_add_u32 s65, s65, 4096
    v_mov_b32 v4, 0
    s_mov_b64 exec, 1
    buffer_store_dwordx2 v[24:25], v4, s[4:7], s65 offen sc1
    s_mov_b64 exec, -1
    s_waitcnt lgkmcnt(4)
    v_mfma_f32_32x32x16_bf16 v[200:215], v[248:251], v[108:111], v[200:215]
    ds_read_b64_tr_b16 v[240:241], v18 offset:55296
    ds_read_b64_tr_b16 v[242:243], v18 offset:55808
    s_add_u32 s37, s73, 917504
    buffer_load_dwordx4 v[96:99], v20, s[52:55], s37 offen
    v_mfma_f32_32x32x16_bf16 v[216:231], v[252:255], v[108:111], v[216:231]
    ds_read_b64_tr_b16 v[244:245], v19 offset:55296
    ds_read_b64_tr_b16 v[246:247], v19 offset:55808
    buffer_load_dwordx4 v[100:103], v21, s[52:55], s37 offen offset:1024
    s_barrier
    s_waitcnt lgkmcnt(4)
    v_mfma_f32_32x32x16_bf16 v[200:215], v[232:235], v[112:115], v[200:215]
    ds_read_b64_tr_b16 v[248:249], v16 offset:16384
    ds_read_b64_tr_b16 v[250:251], v16 offset:16896
    s_add_u32 m0, s71, 2048
    s_add_u32 s35, s73, 589824
    buffer_load_dwordx4 v20, s[52:55], s35 offen lds
    v_mfma_f32_32x32x16_bf16 v[216:231], v[236:239], v[112:115], v[216:231]
    ds_read_b64_tr_b16 v[252:253], v17 offset:16384
    ds_read_b64_tr_b16 v[254:255], v17 offset:16896
    buffer_load_dwordx4 v21, s[52:55], s35 offen offset:1024 lds
    s_waitcnt lgkmcnt(4)
    v_mfma_f32_32x32x16_bf16 v[200:215], v[240:243], v[116:119], v[200:215]
    ds_read_b64_tr_b16 v[232:233], v18 offset:16384
    ds_read_b64_tr_b16 v[234:235], v18 offset:16896
    v_mfma_f32_32x32x16_bf16 v[216:231], v[244:247], v[116:119], v[216:231]
    ds_read_b64_tr_b16 v[236:237], v19 offset:16384
    ds_read_b64_tr_b16 v[238:239], v19 offset:16896
    s_waitcnt lgkmcnt(4)
    v_mfma_f32_32x32x16_bf16 v[200:215], v[248:251], v[120:123], v[200:215]
    ds_read_b64_tr_b16 v[240:241], v16 offset:57344
    ds_read_b64_tr_b16 v[242:243], v16 offset:57856
    s_add_u32 s37, s73, 1048576
    buffer_load_dwordx4 v[104:107], v20, s[52:55], s37 offen
    v_mfma_f32_32x32x16_bf16 v[216:231], v[252:255], v[120:123], v[216:231]
    ds_read_b64_tr_b16 v[244:245], v17 offset:57344
    ds_read_b64_tr_b16 v[246:247], v17 offset:57856
    buffer_load_dwordx4 v[108:111], v21, s[52:55], s37 offen offset:1024
    s_waitcnt lgkmcnt(4)
    v_mfma_f32_32x32x16_bf16 v[200:215], v[232:235], v[124:127], v[200:215]
    ds_read_b64_tr_b16 v[248:249], v18 offset:57344
    ds_read_b64_tr_b16 v[250:251], v18 offset:57856
    s_add_u32 s37, s73, 1179648
    buffer_load_dwordx4 v[112:115], v20, s[52:55], s37 offen
    v_mfma_f32_32x32x16_bf16 v[216:231], v[236:239], v[124:127], v[216:231]
    ds_read_b64_tr_b16 v[252:253], v19 offset:57344
    ds_read_b64_tr_b16 v[254:255], v19 offset:57856
    buffer_load_dwordx4 v[116:119], v21, s[52:55], s37 offen offset:1024
    s_barrier
    s_waitcnt lgkmcnt(4)
    v_mfma_f32_32x32x16_bf16 v[200:215], v[240:243], v[128:131], v[200:215]
    ds_read_b64_tr_b16 v[232:233], v16 offset:4096
    ds_read_b64_tr_b16 v[234:235], v16 offset:4608
    s_add_u32 m0, s71, 14336
    s_add_u32 s35, s73, 720896
    buffer_load_dwordx4 v20, s[52:55], s35 offen lds
    v_mfma_f32_32x32x16_bf16 v[216:231], v[244:247], v[128:131], v[216:231]
    ds_read_b64_tr_b16 v[236:237], v17 offset:4096
    ds_read_b64_tr_b16 v[238:239], v17 offset:4608
    buffer_load_dwordx4 v21, s[52:55], s35 offen offset:1024 lds
    s_waitcnt lgkmcnt(4)
    v_mfma_f32_32x32x16_bf16 v[200:215], v[248:251], v[132:135], v[200:215]
    ds_read_b64_tr_b16 v[240:241], v18 offset:4096
    ds_read_b64_tr_b16 v[242:243], v18 offset:4608
    v_mfma_f32_32x32x16_bf16 v[216:231], v[252:255], v[132:135], v[216:231]
    ds_read_b64_tr_b16 v[244:245], v19 offset:4096
    ds_read_b64_tr_b16 v[246:247], v19 offset:4608
    s_waitcnt lgkmcnt(4)
    v_mfma_f32_32x32x16_bf16 v[200:215], v[232:235], v[136:139], v[200:215]
    ds_read_b64_tr_b16 v[248:249], v16 offset:45056
    ds_read_b64_tr_b16 v[250:251], v16 offset:45568
    s_add_u32 s37, s73, 1310720
    buffer_load_dwordx4 v[120:123], v20, s[52:55], s37 offen
    v_mfma_f32_32x32x16_bf16 v[216:231], v[236:239], v[136:139], v[216:231]
    ds_read_b64_tr_b16 v[252:253], v17 offset:45056
    ds_read_b64_tr_b16 v[254:255], v17 offset:45568
    buffer_load_dwordx4 v[124:127], v21, s[52:55], s37 offen offset:1024
    s_waitcnt lgkmcnt(4)
    v_mfma_f32_32x32x16_bf16 v[200:215], v[240:243], v[140:143], v[200:215]
    ds_read_b64_tr_b16 v[232:233], v18 offset:45056
    ds_read_b64_tr_b16 v[234:235], v18 offset:45568
    s_add_u32 s37, s73, 1441792
    buffer_load_dwordx4 v[128:131], v20, s[52:55], s37 offen
    v_mfma_f32_32x32x16_bf16 v[216:231], v[244:247], v[140:143], v[216:231]
    ds_read_b64_tr_b16 v[236:237], v19 offset:45056
    ds_read_b64_tr_b16 v[238:239], v19 offset:45568
    buffer_load_dwordx4 v[132:135], v21, s[52:55], s37 offen offset:1024
    s_waitcnt lgkmcnt(4)
    v_mfma_f32_32x32x16_bf16 v[200:215], v[248:251], v[144:147], v[200:215]
    v_mfma_f32_32x32x16_bf16 v[216:231], v[252:255], v[144:147], v[216:231]
    s_waitcnt lgkmcnt(0)
    v_mfma_f32_32x32x16_bf16 v[200:215], v[232:235], v[148:151], v[200:215]
    v_mfma_f32_32x32x16_bf16 v[216:231], v[236:239], v[148:151], v[216:231]
    s_mov_b32 s69, 0
L_a_cfpoll1:
    v_xor_b32 v4, s50, v11
    v_xor_b32 v5, s50, v15
    v_or_b32 v4, v4, v5
    v_cmp_ne_u32 vcc, 0, v4
    s_add_u32 s69, s69, 1
    s_cmp_eq_u64 vcc, 0
    s_cbranch_scc1 L_a_cfok1
    s_cmp_ge_u32 s69, 200000
    s_cbranch_scc1 L_a_cfok1
    s_sleep 1
    buffer_load_dwordx4 v[8:11], v22, s[4:7], s76 offen offset:2048 sc1
    buffer_load_dwordx4 v[12:15], v22, s[4:7], s76 offen offset:3072 sc1
    s_waitcnt vmcnt(0)
    s_branch L_a_cfpoll1
L_a_cfok1:
    v_mov_b32 v11, 0
    v_mov_b32 v15, 0
    s_add_u32 s72, s72, 4096
    v_mfma_f32_32x32x16_bf16 v[200:215], v[8:11], v[164:167], v[200:215]
    v_mfma_f32_32x32x16_bf16 v[216:231], v[12:15], v[164:167], v[216:231]
    s_barrier
    v_add_u32 v15, s71, v22
    v_add_u32 v8, s31, v22
    v_add_u32 v9, s32, v22
    s_mov_b32 s65, 4096
    buffer_load_dwordx2 v[12:13], v154, s[4:7], s65 offen sc1
    s_nop 4
    v_mul_f32 v24, v200, v200
    v_mul_f32 v25, v201, v201
    v_mul_f32 v26, v202, v202
    v_mul_f32 v27, v203, v203
    v_fma_f32 v24, v24, v157, v156
    v_fma_f32 v25, v25, v157, v156
    v_fma_f32 v26, v26, v157, v156
    v_fma_f32 v27, v27, v157, v156
    v_mul_f32 v24, v24, v200
    v_mul_f32 v25, v25, v201
    v_mul_f32 v26, v26, v202
    v_mul_f32 v27, v27, v203
    v_exp_f32 v24, v24
    v_exp_f32 v25, v25
    v_exp_f32 v26, v26
    v_exp_f32 v27, v27
    v_fma_f32 v24, v24, v158, v158
    v_fma_f32 v25, v25, v158, v158
    v_fma_f32 v26, v26, v158, v158
    v_fma_f32 v27, v27, v158, v158
    v_rcp_f32 v24, v24
    v_rcp_f32 v25, v25
    v_rcp_f32 v26, v26
    v_rcp_f32 v27, v27
    v_mul_f32 v24, v24, v200
    v_mul_f32 v25, v25, v201
    v_mul_f32 v26, v26, v202
    v_mul_f32 v27, v27, v203
    v_cvt_pk_bf16_f32 v32, v24, v25
    v_cvt_pk_bf16_f32 v33, v26, v27
    v_mul_f32 v28, v204, v204
    v_mul_f32 v29, v205, v205
    v_mul_f32 v30, v206, v206
    v_mul_f32 v31, v207, v207
    v_fma_f32 v28, v28, v157, v156
    v_fma_f32 v29, v29, v157, v156
    v_fma_f32 v30, v30, v157, v156
    v_fma_f32 v31, v31, v157, v156
    v_mul_f32 v28, v28, v204
    v_mul_f32 v29, v29, v205
    v_mul_f32 v30, v30, v206
    v_mul_f32 v31, v31, v207
    v_exp_f32 v28, v28
    v_exp_f32 v29, v29
    v_exp_f32 v30, v30
    v_exp_f32 v31, v31
    v_fma_f32 v28, v28, v158, v158
    v_fma_f32 v29, v29, v158, v158
    v_fma_f32 v30, v30, v158, v158
    v_fma_f32 v31, v31, v158, v158
    v_rcp_f32 v28, v28
    v_rcp_f32 v29, v29
    v_rcp_f32 v30, v30
    v_rcp_f32 v31, v31
    v_mul_f32 v28, v28, v204
    v_mul_f32 v29, v29, v205
    v_mul_f32 v30, v30, v206
    v_mul_f32 v31, v31, v207
    v_cvt_pk_bf16_f32 v34, v28, v29
    v_cvt_pk_bf16_f32 v35, v30, v31
    buffer_store_dwordx4 v[32:35], v22, s[4:7], s72 offen offset:0 sc1
    v_mul_f32 v24, v208, v208
    v_mul_f32 v25, v209, v209
    v_mul_f32 v26, v210, v210
    v_mul_f32 v27, v211, v211
    v_fma_f32 v24, v24, v157, v156
    v_fma_f32 v25, v25, v157, v156
    v_fma_f32 v26, v26, v157, v156
    v_fma_f32 v27, v27, v157, v156
    v_mul_f32 v24, v24, v208
    v_mul_f32 v25, v25, v209
    v_mul_f32 v26, v26, v210
    v_mul_f32 v27, v27, v211
    v_exp_f32 v24, v24
    v_exp_f32 v25, v25
    v_exp_f32 v26, v26
    v_exp_f32 v27, v27
    v_fma_f32 v24, v24, v158, v158
    v_fma_f32 v25, v25, v158, v158
    v_fma_f32 v26, v26, v158, v158
    v_fma_f32 v27, v27, v158, v158
    v_rcp_f32 v24, v24
    v_rcp_f32 v25, v25
    v_rcp_f32 v26, v26
    v_rcp_f32 v27, v27
    v_mul_f32 v24, v24, v208
    v_mul_f32 v25, v25, v209
    v_mul_f32 v26, v26, v210
    v_mul_f32 v27, v27, v211
    v_cvt_pk_bf16_f32 v36, v24, v25
    v_cvt_pk_bf16_f32 v37, v26, v27
    v_mul_f32 v28, v212, v212
    v_mul_f32 v29, v213, v213
    v_mul_f32 v30, v214, v214
    v_mul_f32 v31, v215, v215
    v_fma_f32 v28, v28, v157, v156
    v_fma_f32 v29, v29, v157, v156
    v_fma_f32 v30, v30, v157, v156
    v_fma_f32 v31, v31, v157, v156
    v_mul_f32 v28, v28, v212
    v_mul_f32 v29, v29, v213
    v_mul_f32 v30, v30, v214
    v_mul_f32 v31, v31, v215
    v_exp_f32 v28, v28
    v_exp_f32 v29, v29
    v_exp_f32 v30, v30
    v_exp_f32 v31, v31
    v_fma_f32 v28, v28, v158, v158
    v_fma_f32 v29, v29, v158, v158
    v_fma_f32 v30, v30, v158, v158
    v_fma_f32 v31, v31, v158, v158
    v_rcp_f32 v28, v28
    v_rcp_f32 v29, v29
    v_rcp_f32 v30, v30
    v_rcp_f32 v31, v31
    v_mul_f32 v28, v28, v212
    v_mul_f32 v29, v29, v213
    v_mul_f32 v30, v30, v214
    v_mul_f32 v31, v31, v215
    v_cvt_pk_bf16_f32 v38, v28, v29
    v_cvt_pk_bf16_f32 v39, v30, v31
    buffer_store_dwordx4 v[36:39], v22, s[4:7], s72 offen offset:1024 sc1
    s_mov_b32 s69, 0
L_a_hpoll0:
    s_waitcnt vmcnt(2)
    v_xor_b32 v4, s50, v12
    v_xor_b32 v5, s51, v13
    v_or_b32 v4, v4, v5
    v_cmp_ne_u32 vcc, 0, v4
    s_add_u32 s69, s69, 1
    s_cmp_eq_u64 vcc, 0
    s_cbranch_scc1 L_a_hok0
    s_cmp_ge_u32 s69, 200000
    s_cbranch_scc1 L_a_hok0
    s_mov_b32 s65, 4096
    s_sleep 1
    buffer_load_dwordx2 v[12:13], v154, s[4:7], s65 offen sc1
    s_waitcnt vmcnt(0)
    s_branch L_a_hpoll0
L_a_hok0:
    v_mul_f32 v24, v216, v216
    v_mul_f32 v25, v217, v217
    v_mul_f32 v26, v218, v218
    v_mul_f32 v27, v219, v219
    v_fma_f32 v24, v24, v157, v156
    v_fma_f32 v25, v25, v157, v156
    v_fma_f32 v26, v26, v157, v156
    s_add_u32 s36, s30, 0
    buffer_load_dwordx4 v[232:235], v8, s[4:7], s36 offen sc1
    v_fma_f32 v27, v27, v157, v156
    v_mul_f32 v24, v24, v216
    v_mul_f32 v25, v25, v217
    v_mul_f32 v26, v26, v218
    v_mul_f32 v27, v27, v219
    v_exp_f32 v24, v24
    v_exp_f32 v25, v25
    v_exp_f32 v26, v26
    buffer_load_dwordx4 v[236:239], v9, s[4:7], s36 offen sc1
    v_exp_f32 v27, v27
    v_fma_f32 v24, v24, v158, v158
    v_fma_f32 v25, v25, v158, v158
    v_fma_f32 v26, v26, v158, v158
    v_fma_f32 v27, v27, v158, v158
    v_rcp_f32 v24, v24
    v_rcp_f32 v25, v25
    v_rcp_f32 v26, v26
    s_add_u32 s36, s30, 8192
    buffer_load_dwordx4 v[240:243], v8, s[4:7], s36 offen sc1
    v_rcp_f32 v27, v27
    v_mul_f32 v24, v24, v216
    v_mul_f32 v25, v25, v217
    v_mul_f32 v26, v26, v218
    v_mul_f32 v27, v27, v219
    v_cvt_pk_bf16_f32 v32, v24, v25
    v_cvt_pk_bf16_f32 v33, v26, v27
    v_mul_f32 v28, v220, v220
    buffer_load_dwordx4 v[244:247], v9, s[4:7], s36 offen sc1
    v_mul_f32 v29, v221, v221
    v_mul_f32 v30, v222, v222
    v_mul_f32 v31, v223, v223
    v_fma_f32 v28, v28, v157, v156
    v_fma_f32 v29, v29, v157, v156
    v_fma_f32 v30, v30, v157, v156
    v_fma_f32 v31, v31, v157, v156
    v_mul_f32 v28, v28, v220
    s_add_u32 s36, s30, 16384
    buffer_load_dwordx4 v[248:251], v8, s[4:7], s36 offen sc1
    v_mul_f32 v29, v29, v221
    v_mul_f32 v30, v30, v222
    v_mul_f32 v31, v31, v223
    v_exp_f32 v28, v28
    v_exp_f32 v29, v29
    v_exp_f32 v30, v30
    v_exp_f32 v31, v31
    v_fma_f32 v28, v28, v158, v158
    buffer_load_dwordx4 v[252:255], v9, s[4:7], s36 offen sc1
    v_fma_f32 v29, v29, v158, v158
    v_fma_f32 v30, v30, v158, v158
    v_fma_f32 v31, v31, v158, v158
    v_rcp_f32 v28, v28
    v_rcp_f32 v29, v29
    v_rcp_f32 v30, v30
    v_rcp_f32 v31, v31
    v_mul_f32 v28, v28, v220
    v_mul_f32 v29, v29, v221
    v_mul_f32 v30, v30, v222
    v_mul_f32 v31, v31, v223
    v_cvt_pk_bf16_f32 v34, v28, v29
    v_cvt_pk_bf16_f32 v35, v30, v31
    buffer_store_dwordx4 v[32:35], v22, s[4:7], s72 offen offset:2048 sc1
    v_mul_f32 v24, v224, v224
    v_mul_f32 v25, v225, v225
    v_mul_f32 v26, v226, v226
    v_mul_f32 v27, v227, v227
    v_fma_f32 v24, v24, v157, v156
    v_fma_f32 v25, v25, v157, v156
    v_fma_f32 v26, v26, v157, v156
    v_fma_f32 v27, v27, v157, v156
    v_mul_f32 v24, v24, v224
    v_mul_f32 v25, v25, v225
    v_mul_f32 v26, v26, v226
    v_mul_f32 v27, v27, v227
    v_exp_f32 v24, v24
    v_exp_f32 v25, v25
    v_exp_f32 v26, v26
    v_exp_f32 v27, v27
    v_fma_f32 v24, v24, v158, v158
    v_fma_f32 v25, v25, v158, v158
    v_fma_f32 v26, v26, v158, v158
    v_fma_f32 v27, v27, v158, v158
    v_rcp_f32 v24, v24
    v_rcp_f32 v25, v25
    v_rcp_f32 v26, v26
    v_rcp_f32 v27, v27
    v_mul_f32 v24, v24, v224
    v_mul_f32 v25, v25, v225
    v_mul_f32 v26, v26, v226
    v_mul_f32 v27, v27, v227
    v_cvt_pk_bf16_f32 v36, v24, v25
    v_cvt_pk_bf16_f32 v37, v26, v27
    v_mul_f32 v28, v228, v228
    v_mul_f32 v29, v229, v229
    v_mul_f32 v30, v230, v230
    v_mul_f32 v31, v231, v231
    v_fma_f32 v28, v28, v157, v156
    v_fma_f32 v29, v29, v157, v156
    v_fma_f32 v30, v30, v157, v156
    v_fma_f32 v31, v31, v157, v156
    v_mul_f32 v28, v28, v228
    v_mul_f32 v29, v29, v229
    v_mul_f32 v30, v30, v230
    v_mul_f32 v31, v31, v231
    v_exp_f32 v28, v28
    v_exp_f32 v29, v29
    v_exp_f32 v30, v30
    v_exp_f32 v31, v31
    v_fma_f32 v28, v28, v158, v158
    v_fma_f32 v29, v29, v158, v158
    v_fma_f32 v30, v30, v158, v158
    v_fma_f32 v31, v31, v158, v158
    v_rcp_f32 v28, v28
    v_rcp_f32 v29, v29
    v_rcp_f32 v30, v30
    v_rcp_f32 v31, v31
    v_mul_f32 v28, v28, v228
    v_mul_f32 v29, v29, v229
    v_mul_f32 v30, v30, v230
    v_mul_f32 v31, v31, v231
    v_cvt_pk_bf16_f32 v38, v28, v29
    v_cvt_pk_bf16_f32 v39, v30, v31
    buffer_store_dwordx4 v[36:39], v22, s[4:7], s72 offen offset:3072 sc1
    s_waitcnt vmcnt(0)
    v_mov_b32 v10, s50
    v_mov_b32 v11, s51
    s_lshl_b32 s65, s60, 2
    s_add_u32 s65, s65, s3
    s_lshl_b32 s65, s65, 6
    s_add_u32 s65, s65, 69632
    v_mov_b32 v4, 0
    s_mov_b64 exec, 1
    buffer_store_dwordx2 v[10:11], v4, s[4:7], s65 offen sc1
    s_mov_b64 exec, -1
    s_branch L_a_g2
L_a_nog1:
    s_sub_u32 s63, s62, 28
    s_lshl_b32 s63, s63, 3
    s_add_u32 s63, s63, s61
    s_cmp_ge_u32 s63, 28
    s_cbranch_scc1 L_a_nocf
    s_lshr_b32 s64, s63, 1
    s_and_b32 s66, s63, 1
    s_lshl_b32 s70, s66, 2
    s_add_u32 s70, s70, s3
    s_mul_i32 s70, s70, 229376
    s_lshl_b32 s65, s64, 8
    s_add_u32 s70, s70, s65
    s_add_u32 m0, s71, 0
    s_add_u32 s28, s70, 0
    buffer_load_dwordx4 v160, s[12:15], s28 offen lds
    buffer_load_dwordx4 v161, s[12:15], s28 offen offset:1024 lds
    s_add_u32 m0, s71, 2048
    s_add_u32 s28, s70, 57344
    buffer_load_dwordx4 v160, s[12:15], s28 offen lds
    buffer_load_dwordx4 v161, s[12:15], s28 offen offset:1024 lds
    s_add_u32 m0, s71, 4096
    s_add_u32 s28, s70, 114688
    buffer_load_dwordx4 v160, s[12:15], s28 offen lds
    buffer_load_dwordx4 v161, s[12:15], s28 offen offset:1024 lds
    s_add_u32 m0, s71, 6144
    s_add_u32 s28, s70, 172032
    buffer_load_dwordx4 v160, s[12:15], s28 offen lds
    buffer_load_dwordx4 v161, s[12:15], s28 offen offset:1024 lds
    v_lshl_add_u32 v4, v1, 1, s65
    global_load_ushort v36, v4, s[38:39]
    global_load_ushort v37, v4, s[38:39] offset:128
    s_add_u32 m0, s71, 8192
    s_add_u32 s28, s70, 128
    buffer_load_dwordx4 v160, s[12:15], s28 offen lds
    buffer_load_dwordx4 v161, s[12:15], s28 offen offset:1024 lds
    s_add_u32 m0, s71, 10240
    s_add_u32 s28, s70, 57472
    buffer_load_dwordx4 v160, s[12:15], s28 offen lds
    buffer_load_dwordx4 v161, s[12:15], s28 offen offset:1024 lds
    s_add_u32 m0, s71, 12288
    s_add_u32 s28, s70, 114816
    buffer_load_dwordx4 v160, s[12:15], s28 offen lds
    buffer_load_dwordx4 v161, s[12:15], s28 offen offset:1024 lds
    s_add_u32 m0, s71, 14336
    s_add_u32 s28, s70, 172160
    buffer_load_dwordx4 v160, s[12:15], s28 offen lds
    buffer_load_dwordx4 v161, s[12:15], s28 offen offset:1024 lds
    v_lshrrev_b32 v4, 5, v1
    v_lshlrev_b32 v4, 10, v4
    v_bfe_u32 v5, v1, 2, 2
    v_lshl_add_u32 v4, v5, 7, v4
    v_bfe_u32 v5, v1, 4, 1
    v_lshl_add_u32 v4, v5, 5, v4
    v_and_b32 v5, 3, v1
    v_lshl_add_u32 v4, v5, 3, v4
    v_bfe_u32 v5, v1, 3, 1
    v_lshl_add_u32 v16, v5, 6, v4
    v_add_u32 v16, s71, v16
    v_xor_b32 v17, 64, v16
    v_and_b32 v38, 15, v1
    v_lshrrev_b32 v39, 4, v1
    v_xor_b32 v4, v39, v38
    v_and_b32 v4, 1, v4
    v_cmp_eq_u32 vcc, 0, v4
    v_mov_b32 v5, 0x3f803f80
    s_nop 0
    v_cndmask_b32 v24, 0, v5, vcc
    v_mov_b32 v25, v24
    v_mov_b32 v26, v24
    v_mov_b32 v27, v24
    v_lshlrev_b32 v40, 6, v38
    v_lshl_add_u32 v40, v39, 4, v40
    v_add_u32 v40, s71, v40
    v_lshlrev_b32 v41, 2, v1
    v_add_u32 v42, 40960, v41
    v_and_b32 v4, 31, v1
    v_lshlrev_b32 v43, 4, v4
    v_lshrrev_b32 v4, 5, v1
    v_lshl_add_u32 v43, v4, 10, v43
    s_lshl_b32 s29, s64, 12
    s_lshl_b32 s28, s66, 9
    s_add_u32 s29, s29, s28
    s_add_u32 s29, s29, 262144
    s_mov_b32 s74, 0x00030003
    s_mov_b32 s75, 0x00030003
    s_sub_u32 s28, s66, 1
    s_waitcnt vmcnt(16)
    ds_read_b64_tr_b16 v[48:49], v16 offset:0
    ds_read_b64_tr_b16 v[50:51], v16 offset:512
    ds_read_b64_tr_b16 v[52:53], v17 offset:0
    ds_read_b64_tr_b16 v[54:55], v17 offset:512
    s_waitcnt vmcnt(14)
    ds_read_b64_tr_b16 v[56:57], v16 offset:2048
    ds_read_b64_tr_b16 v[58:59], v16 offset:2560
    ds_read_b64_tr_b16 v[60:61], v17 offset:2048
    ds_read_b64_tr_b16 v[62:63], v17 offset:2560
    s_waitcnt vmcnt(12)
    ds_read_b64_tr_b16 v[64:65], v16 offset:4096
    ds_read_b64_tr_b16 v[66:67], v16 offset:4608
    ds_read_b64_tr_b16 v[68:69], v17 offset:4096
    ds_read_b64_tr_b16 v[70:71], v17 offset:4608
    s_waitcnt vmcnt(10)
    ds_read_b64_tr_b16 v[72:73], v16 offset:6144
    ds_read_b64_tr_b16 v[74:75], v16 offset:6656
    ds_read_b64_tr_b16 v[76:77], v17 offset:6144
    ds_read_b64_tr_b16 v[78:79], v17 offset:6656
    s_waitcnt lgkmcnt(12)
    v_mfma_f32_16x16x32_bf16 v[28:31], v[48:51], v[24:27], 0
    v_mfma_f32_16x16x32_bf16 v[32:35], v[52:55], v[24:27], 0
    s_waitcnt lgkmcnt(8)
    v_mfma_f32_16x16x32_bf16 v[28:31], v[56:59], v[24:27], v[28:31]
    v_mfma_f32_16x16x32_bf16 v[32:35], v[60:63], v[24:27], v[32:35]
    s_waitcnt lgkmcnt(4)
    v_mfma_f32_16x16x32_bf16 v[28:31], v[64:67], v[24:27], v[28:31]
    v_mfma_f32_16x16x32_bf16 v[32:35], v[68:71], v[24:27], v[32:35]
    s_waitcnt lgkmcnt(0)
    v_mfma_f32_16x16x32_bf16 v[28:31], v[72:75], v[24:27], v[28:31]
    v_mfma_f32_16x16x32_bf16 v[32:35], v[76:79], v[24:27], v[32:35]
    s_waitcnt vmcnt(8)
    v_readfirstlane_b32 s50, v2
    s_nop 0
    s_mul_i32 s50, s50, 0x9E3779B1
    s_add_u32 s50, s50, 0x7F4A7C15
    s_xor_b32 s51, s50, 0x5bd1e995
    s_mov_b64 exec, s[74:75]
    ds_write_b128 v40, v[28:31] offset:16384
    ds_write_b128 v40, v[32:35] offset:16512
    s_mov_b64 exec, -1
    v_and_b32 v36, s28, v36
    s_waitcnt lgkmcnt(0)
    s_barrier
    ds_read_b32 v48, v41 offset:16384
    ds_read_b32 v49, v41 offset:36864
    ds_read_b32 v50, v42 offset:16384
    ds_read_b32 v51, v42 offset:36864
    s_waitcnt lgkmcnt(0)
    v_add_f32 v48, v48, v49
    v_add_f32 v50, v50, v51
    v_add_f32 v48, v48, v50
    v_cvt_pk_bf16_f32 v49, v48, v48
    v_and_b32 v50, 0xffff0000, v49
    v_sub_f32 v51, v48, v50
    v_cvt_pk_bf16_f32 v84, v48, v51
    v_and_b32 v49, 0xffff, v49
    v_lshl_or_b32 v85, v36, 16, v49
    v_mov_b32 v86, v36
    v_mov_b32 v87, s50
    s_cmp_lg_u32 s3, 0
    s_cbranch_scc1 L_a_nocf20
    buffer_store_dwordx4 v[84:87], v43, s[4:7], s29 offen offset:0 sc1
L_a_nocf20:
    s_waitcnt vmcnt(6)
    ds_read_b64_tr_b16 v[48:49], v16 offset:8192
    ds_read_b64_tr_b16 v[50:51], v16 offset:8704
    ds_read_b64_tr_b16 v[52:53], v17 offset:8192
    ds_read_b64_tr_b16 v[54:55], v17 offset:8704
    s_waitcnt vmcnt(4)
    ds_read_b64_tr_b16 v[56:57], v16 offset:10240
    ds_read_b64_tr_b16 v[58:59], v16 offset:10752
    ds_read_b64_tr_b16 v[60:61], v17 offset:10240
    ds_read_b64_tr_b16 v[62:63], v17 offset:10752
    s_waitcnt vmcnt(2)
    ds_read_b64_tr_b16 v[64:65], v16 offset:12288
    ds_read_b64_tr_b16 v[66:67], v16 offset:12800
    ds_read_b64_tr_b16 v[68:69], v17 offset:12288
    ds_read_b64_tr_b16 v[70:71], v17 offset:12800
    s_waitcnt vmcnt(0)
    ds_read_b64_tr_b16 v[72:73], v16 offset:14336
    ds_read_b64_tr_b16 v[74:75], v16 offset:14848
    ds_read_b64_tr_b16 v[76:77], v17 offset:14336
    ds_read_b64_tr_b16 v[78:79], v17 offset:14848
    s_waitcnt lgkmcnt(12)
    v_mfma_f32_16x16x32_bf16 v[28:31], v[48:51], v[24:27], 0
    v_mfma_f32_16x16x32_bf16 v[32:35], v[52:55], v[24:27], 0
    s_waitcnt lgkmcnt(8)
    v_mfma_f32_16x16x32_bf16 v[28:31], v[56:59], v[24:27], v[28:31]
    v_mfma_f32_16x16x32_bf16 v[32:35], v[60:63], v[24:27], v[32:35]
    s_waitcnt lgkmcnt(4)
    v_mfma_f32_16x16x32_bf16 v[28:31], v[64:67], v[24:27], v[28:31]
    v_mfma_f32_16x16x32_bf16 v[32:35], v[68:71], v[24:27], v[32:35]
    s_waitcnt lgkmcnt(0)
    v_mfma_f32_16x16x32_bf16 v[28:31], v[72:75], v[24:27], v[28:31]
    v_mfma_f32_16x16x32_bf16 v[32:35], v[76:79], v[24:27], v[32:35]
    s_mov_b64 exec, s[74:75]
    s_nop 5
    ds_write_b128 v40, v[28:31] offset:18432
    ds_write_b128 v40, v[32:35] offset:18560
    s_mov_b64 exec, -1
    v_and_b32 v37, s28, v37
    s_waitcnt lgkmcnt(0)
    s_barrier
    ds_read_b32 v48, v41 offset:18432
    ds_read_b32 v49, v41 offset:38912
    ds_read_b32 v50, v42 offset:18432
    ds_read_b32 v51, v42 offset:38912
    s_waitcnt lgkmcnt(0)
    v_add_f32 v48, v48, v49
    v_add_f32 v50, v50, v51
    v_add_f32 v48, v48, v50
    v_cvt_pk_bf16_f32 v49, v48, v48
    v_and_b32 v50, 0xffff0000, v49
    v_sub_f32 v51, v48, v50
    v_cvt_pk_bf16_f32 v84, v48, v51
    v_and_b32 v49, 0xffff, v49
    v_lshl_or_b32 v85, v37, 16, v49
    v_mov_b32 v86, v37
    v_mov_b32 v87, s50
    s_cmp_lg_u32 s3, 1
    s_cbranch_scc1 L_a_nocf21
    buffer_store_dwordx4 v[84:87], v43, s[4:7], s29 offen offset:2048 sc1
L_a_nocf21:
    s_barrier
L_a_nocf:
    s_waitcnt vmcnt(0)
    s_barrier
    v_readfirstlane_b32 s50, v2
    s_nop 0
    s_mul_i32 s50, s50, 0x9E3779B1
    s_add_u32 s50, s50, 0x7F4A7C15
    s_xor_b32 s51, s50, 0x5bd1e995
    s_mov_b32 s52, s40
    s_mov_b32 s53, s41
    s_mov_b32 s54, 1835008
    s_mov_b32 s55, 0x20000
    s_mov_b32 s56, s44
    s_mov_b32 s57, s45
    s_mov_b32 s58, 2097152
    s_mov_b32 s59, 0x20000
    s_lshl_b32 s78, s61, 2
    s_lshr_b32 s65, s62, 3
    s_add_u32 s78, s78, s65
    s_and_b32 s79, s62, 7
    s_lshr_b32 s66, s3, 1
    s_and_b32 s67, s3, 1
    v_lshrrev_b32 v4, 3, v1
    v_lshlrev_b32 v20, 10, v4
    v_and_b32 v4, 7, v1
    v_bfe_u32 v5, v1, 4, 1
    v_lshlrev_b32 v5, 1, v5
    v_xor_b32 v4, v4, v5
    v_lshl_add_u32 v20, v4, 4, v20
    v_add_u32 v21, 7168, v20
    s_lshl_b32 s73, s3, 14
    s_lshl_b32 s65, s79, 7
    s_add_u32 s73, s73, s65
    v_lshlrev_b32 v22, 4, v1
    v_lshrrev_b32 v6, 5, v1
    v_lshlrev_b32 v6, 9, v6
    v_bfe_u32 v7, v1, 2, 2
    v_lshl_add_u32 v6, v7, 7, v6
    v_and_b32 v7, 1, v1
    v_lshl_add_u32 v6, v7, 6, v6
    v_bfe_u32 v7, v1, 4, 1
    v_lshl_add_u32 v6, v7, 4, v6
    v_bfe_u32 v7, v1, 1, 1
    v_lshl_add_u32 v6, v7, 3, v6
    v_bfe_u32 v7, v1, 3, 1
    v_xor_b32 v7, s67, v7
    v_lshl_add_u32 v6, v7, 5, v6
    v_add_u32 v152, s71, v6
    v_xor_b32 v153, 32, v152
    v_min_u32 v7, 27, v1
    v_lshrrev_b32 v6, 1, v7
    v_mul_u32_u24 v154, 37, v6
    v_lshrrev_b32 v154, 8, v154
    v_mul_u32_u24 v155, 7, v154
    v_sub_u32 v6, v6, v155
    s_lshr_b32 s28, s78, 1
    s_and_b32 s29, s28, 3
    s_mul_i32 s29, s29, 7
    v_add_u32 v6, s29, v6
    s_lshr_b32 s28, s28, 2
    s_lshl_b32 s28, s28, 1
    v_add_u32 v154, s28, v154
    v_lshl_add_u32 v6, v6, 3, v154
    s_and_b32 s28, s78, 1
    s_lshl_b32 s28, s28, 1
    v_and_b32 v7, 1, v7
    v_add_u32 v7, s28, v7
    v_lshl_add_u32 v6, v6, 2, v7
    v_lshlrev_b32 v154, 6, v6
    s_mul_i32 s30, s78, 229376
    s_lshl_b32 s28, s3, 10
    s_add_u32 s30, s30, s28
    s_add_u32 s30, s30, 5242880
    s_mul_i32 s31, s66, 114688
    s_sub_u32 s32, 114688, s31
    v_add_u32 v15, s71, v22
    v_add_u32 v8, s31, v22
    v_add_u32 v9, s32, v22
    v_mov_b32 v10, s50
    v_mov_b32 v11, s51
    s_lshl_b32 s65, s60, 2
    s_add_u32 s65, s65, s3
    s_lshl_b32 s65, s65, 6
    s_add_u32 s65, s65, 4096
    v_mov_b32 v4, 0
    s_mov_b64 exec, 1
    buffer_store_dwordx2 v[10:11], v4, s[4:7], s65 offen sc1
    s_mov_b64 exec, -1
    v_mov_b32 v10, s50
    v_mov_b32 v11, s51
    s_lshl_b32 s65, s60, 2
    s_add_u32 s65, s65, s3
    s_lshl_b32 s65, s65, 6
    s_add_u32 s65, s65, 69632
    v_mov_b32 v4, 0
    s_mov_b64 exec, 1
    buffer_store_dwordx2 v[10:11], v4, s[4:7], s65 offen sc1
    s_mov_b64 exec, -1
    s_add_u32 s37, s73, 0
    buffer_load_dwordx4 v[40:43], v20, s[52:55], s37 offen
    buffer_load_dwordx4 v[44:47], v21, s[52:55], s37 offen offset:1024
    s_add_u32 s37, s73, 131072
    buffer_load_dwordx4 v[48:51], v20, s[52:55], s37 offen
    buffer_load_dwordx4 v[52:55], v21, s[52:55], s37 offen offset:1024
    s_add_u32 s37, s73, 262144
    buffer_load_dwordx4 v[56:59], v20, s[52:55], s37 offen
    buffer_load_dwordx4 v[60:63], v21, s[52:55], s37 offen offset:1024
    s_add_u32 s37, s73, 393216
    buffer_load_dwordx4 v[64:67], v20, s[52:55], s37 offen
    buffer_load_dwordx4 v[68:71], v21, s[52:55], s37 offen offset:1024
    s_add_u32 s37, s73, 524288
    buffer_load_dwordx4 v[72:75], v20, s[52:55], s37 offen
    buffer_load_dwordx4 v[76:79], v21, s[52:55], s37 offen offset:1024
    s_add_u32 s37, s73, 655360
    buffer_load_dwordx4 v[80:83], v20, s[52:55], s37 offen
    buffer_load_dwordx4 v[84:87], v21, s[52:55], s37 offen offset:1024
    s_add_u32 s37, s73, 786432
    buffer_load_dwordx4 v[88:91], v20, s[52:55], s37 offen
    buffer_load_dwordx4 v[92:95], v21, s[52:55], s37 offen offset:1024
    s_add_u32 s37, s73, 917504
    buffer_load_dwordx4 v[96:99], v20, s[52:55], s37 offen
    buffer_load_dwordx4 v[100:103], v21, s[52:55], s37 offen offset:1024
    s_add_u32 s37, s73, 1048576
    buffer_load_dwordx4 v[104:107], v20, s[52:55], s37 offen
    buffer_load_dwordx4 v[108:111], v21, s[52:55], s37 offen offset:1024
    s_add_u32 s37, s73, 1179648
    buffer_load_dwordx4 v[112:115], v20, s[52:55], s37 offen
    buffer_load_dwordx4 v[116:119], v21, s[52:55], s37 offen offset:1024
    s_add_u32 s37, s73, 1310720
    buffer_load_dwordx4 v[120:123], v20, s[52:55], s37 offen
    buffer_load_dwordx4 v[124:127], v21, s[52:55], s37 offen offset:1024
    s_add_u32 s37, s73, 1441792
    buffer_load_dwordx4 v[128:131], v20, s[52:55], s37 offen
    buffer_load_dwordx4 v[132:135], v21, s[52:55], s37 offen offset:1024
    s_add_u32 m0, s71, 6144
    s_add_u32 s35, s73, 1572864
    buffer_load_dwordx4 v20, s[52:55], s35 offen lds
    buffer_load_dwordx4 v21, s[52:55], s35 offen offset:1024 lds
    s_add_u32 m0, s71, 18432
    s_add_u32 s35, s73, 1703936
    buffer_load_dwordx4 v20, s[52:55], s35 offen lds
    buffer_load_dwordx4 v21, s[52:55], s35 offen offset:1024 lds
    s_add_u32 m0, s71, 8192
    s_add_u32 s35, s73, 65536
    buffer_load_dwordx4 v20, s[52:55], s35 offen lds
    buffer_load_dwordx4 v21, s[52:55], s35 offen offset:1024 lds
    s_add_u32 m0, s71, 10240
    s_add_u32 s35, s73, 196608
    buffer_load_dwordx4 v20, s[52:55], s35 offen lds
    buffer_load_dwordx4 v21, s[52:55], s35 offen offset:1024 lds
    s_add_u32 m0, s71, 12288
    s_add_u32 s35, s73, 327680
    buffer_load_dwordx4 v20, s[52:55], s35 offen lds
    buffer_load_dwordx4 v21, s[52:55], s35 offen offset:1024 lds
    s_add_u32 m0, s71, 0
    s_add_u32 s35, s73, 458752
    buffer_load_dwordx4 v20, s[52:55], s35 offen lds
    buffer_load_dwordx4 v21, s[52:55], s35 offen offset:1024 lds
    s_add_u32 m0, s71, 2048
    s_add_u32 s35, s73, 589824
    buffer_load_dwordx4 v20, s[52:55], s35 offen lds
    buffer_load_dwordx4 v21, s[52:55], s35 offen offset:1024 lds
    s_add_u32 m0, s71, 14336
    s_add_u32 s35, s73, 720896
    buffer_load_dwordx4 v20, s[52:55], s35 offen lds
    buffer_load_dwordx4 v21, s[52:55], s35 offen offset:1024 lds
    s_mov_b32 s65, 4096
    buffer_load_dwordx2 v[12:13], v154, s[4:7], s65 offen sc1
    s_mov_b32 s69, 0
L_a_hpoll0i:
    s_waitcnt vmcnt(0)
    v_xor_b32 v4, s50, v12
    v_xor_b32 v5, s51, v13
    v_or_b32 v4, v4, v5
    v_cmp_ne_u32 vcc, 0, v4
    s_add_u32 s69, s69, 1
    s_cmp_eq_u64 vcc, 0
    s_cbranch_scc1 L_a_hok0i
    s_cmp_ge_u32 s69, 200000
    s_cbranch_scc1 L_a_hok0i
    s_mov_b32 s65, 4096
    s_sleep 1
    buffer_load_dwordx2 v[12:13], v154, s[4:7], s65 offen sc1
    s_waitcnt vmcnt(0)
    s_branch L_a_hpoll0i
L_a_hok0i:
    s_add_u32 s36, s30, 0
    buffer_load_dwordx4 v[232:235], v8, s[4:7], s36 offen sc1
    buffer_load_dwordx4 v[236:239], v9, s[4:7], s36 offen sc1
    s_add_u32 s36, s30, 8192
    buffer_load_dwordx4 v[240:243], v8, s[4:7], s36 offen sc1
    buffer_load_dwordx4 v[244:247], v9, s[4:7], s36 offen sc1
    s_add_u32 s36, s30, 16384
    buffer_load_dwordx4 v[248:251], v8, s[4:7], s36 offen sc1
    buffer_load_dwordx4 v[252:255], v9, s[4:7], s36 offen sc1
    s_waitcnt vmcnt(0)
L_a_g2:
    ds_write_b128 v15, v[40:43] offset:16384
    ds_write_b128 v15, v[44:47] offset:17408
    ds_read_b64_tr_b16 v[148:149], v153 offset:16384
    ds_read_b64_tr_b16 v[150:151], v153 offset:17408
    ds_read_b64_tr_b16 v[144:145], v152 offset:16384
    ds_read_b64_tr_b16 v[146:147], v152 offset:17408
    s_waitcnt lgkmcnt(0)
    v_mfma_f32_32x32x16_bf16 v[216:231], v[148:151], v[236:239], 0
    ds_write_b128 v15, v[48:51] offset:4096
    ds_write_b128 v15, v[52:55] offset:5120
    s_add_u32 s36, s30, 24576
    buffer_load_dwordx4 v[32:35], v8, s[4:7], s36 offen sc1
    v_and_b32 v6, 31, v1
    v_mfma_f32_32x32x16_bf16 v[200:215], v[144:147], v[236:239], 0
    ds_read_b64_tr_b16 v[140:141], v153 offset:4096
    ds_read_b64_tr_b16 v[142:143], v153 offset:5120
    buffer_load_dwordx4 v[36:39], v9, s[4:7], s36 offen sc1
    v_lshlrev_b32 v16, 10, v6
    v_mfma_f32_32x32x16_bf16 v[184:199], v[148:151], v[232:235], 0
    ds_read_b64_tr_b16 v[136:137], v152 offset:4096
    ds_read_b64_tr_b16 v[138:139], v152 offset:5120
    s_add_u32 s36, s30, 32768
    buffer_load_dwordx4 v[24:27], v8, s[4:7], s36 offen sc1
    v_lshrrev_b32 v6, 5, v1
    v_mfma_f32_32x32x16_bf16 v[168:183], v[144:147], v[232:235], 0
    buffer_load_dwordx4 v[28:31], v9, s[4:7], s36 offen sc1
    v_lshl_add_u32 v16, v6, 6, v16
    s_waitcnt lgkmcnt(0)
    v_mfma_f32_32x32x16_bf16 v[216:231], v[140:143], v[244:247], v[216:231]
    ds_write_b128 v15, v[56:59] offset:16384
    ds_write_b128 v15, v[60:63] offset:17408
    s_add_u32 s36, s30, 40960
    buffer_load_dwordx4 v[40:43], v8, s[4:7], s36 offen sc1
    s_lshl_b32 s26, s78, 16
    v_mfma_f32_32x32x16_bf16 v[200:215], v[136:139], v[244:247], v[200:215]
    ds_read_b64_tr_b16 v[148:149], v153 offset:16384
    ds_read_b64_tr_b16 v[150:151], v153 offset:17408
    buffer_load_dwordx4 v[44:47], v9, s[4:7], s36 offen sc1
    s_lshl_b32 s28, s66, 15
    v_mfma_f32_32x32x16_bf16 v[184:199], v[140:143], v[240:243], v[184:199]
    ds_read_b64_tr_b16 v[144:145], v152 offset:16384
    ds_read_b64_tr_b16 v[146:147], v152 offset:17408
    s_add_u32 s36, s30, 49152
    buffer_load_dwordx4 v[48:51], v8, s[4:7], s36 offen sc1
    s_add_u32 s26, s26, s28
    v_mfma_f32_32x32x16_bf16 v[168:183], v[136:139], v[240:243], v[168:183]
    buffer_load_dwordx4 v[52:55], v9, s[4:7], s36 offen sc1
    s_lshl_b32 s29, s79, 7
    s_waitcnt lgkmcnt(0)
    v_mfma_f32_32x32x16_bf16 v[216:231], v[148:151], v[252:255], v[216:231]
    ds_write_b128 v15, v[64:67] offset:4096
    ds_write_b128 v15, v[68:71] offset:5120
    s_add_u32 s36, s30, 57344
    buffer_load_dwordx4 v[232:235], v8, s[4:7], s36 offen sc1
    s_lshl_b32 s28, s67, 5
    v_mfma_f32_32x32x16_bf16 v[200:215], v[144:147], v[252:255], v[200:215]
    ds_read_b64_tr_b16 v[140:141], v153 offset:4096
    ds_read_b64_tr_b16 v[142:143], v153 offset:5120
    buffer_load_dwordx4 v[236:239], v9, s[4:7], s36 offen sc1
    s_add_u32 s29, s29, s28
    v_mfma_f32_32x32x16_bf16 v[184:199], v[148:151], v[248:251], v[184:199]
    ds_read_b64_tr_b16 v[136:137], v152 offset:4096
    ds_read_b64_tr_b16 v[138:139], v152 offset:5120
    s_add_u32 s36, s30, 65536
    buffer_load_dwordx4 v[56:59], v8, s[4:7], s36 offen sc1
    s_add_u32 s26, s26, s29
    v_mfma_f32_32x32x16_bf16 v[168:183], v[144:147], v[248:251], v[168:183]
    buffer_load_dwordx4 v[60:63], v9, s[4:7], s36 offen sc1
    v_lshl_add_u32 v14, v6, 6, s29
    s_waitcnt vmcnt(10)
    s_waitcnt lgkmcnt(0)
    v_mfma_f32_32x32x16_bf16 v[216:231], v[140:143], v[36:39], v[216:231]
    ds_write_b128 v15, v[72:75] offset:16384
    ds_write_b128 v15, v[76:79] offset:17408
    s_add_u32 s36, s30, 73728
    buffer_load_dwordx4 v[240:243], v8, s[4:7], s36 offen sc1
    v_lshrrev_b32 v6, 2, v1
    v_mfma_f32_32x32x16_bf16 v[200:215], v[136:139], v[36:39], v[200:215]
    ds_read_b64_tr_b16 v[148:149], v153 offset:16384
    ds_read_b64_tr_b16 v[150:151], v153 offset:17408
    buffer_load_dwordx4 v[244:247], v9, s[4:7], s36 offen sc1
    v_lshlrev_b32 v17, 12, v6
    v_mfma_f32_32x32x16_bf16 v[184:199], v[140:143], v[32:35], v[184:199]
    ds_read_b64_tr_b16 v[144:145], v152 offset:16384
    ds_read_b64_tr_b16 v[146:147], v152 offset:17408
    s_add_u32 s36, s30, 81920
    buffer_load_dwordx4 v[64:67], v8, s[4:7], s36 offen sc1
    v_and_b32 v6, 3, v1
    v_mfma_f32_32x32x16_bf16 v[168:183], v[136:139], v[32:35], v[168:183]
    buffer_load_dwordx4 v[68:71], v9, s[4:7], s36 offen sc1
    v_lshl_add_u32 v17, v6, 4, v17
    s_waitcnt vmcnt(12)
    s_waitcnt lgkmcnt(0)
    v_mfma_f32_32x32x16_bf16 v[216:231], v[148:151], v[28:31], v[216:231]
    ds_write_b128 v15, v[80:83] offset:4096
    ds_write_b128 v15, v[84:87] offset:5120
    s_add_u32 s36, s30, 90112
    buffer_load_dwordx4 v[248:251], v8, s[4:7], s36 offen sc1
    s_lshl_b32 s27, s79, 18
    v_mfma_f32_32x32x16_bf16 v[200:215], v[144:147], v[28:31], v[200:215]
    ds_read_b64_tr_b16 v[140:141], v153 offset:4096
    ds_read_b64_tr_b16 v[142:143], v153 offset:5120
    buffer_load_dwordx4 v[252:255], v9, s[4:7], s36 offen sc1
    s_lshl_b32 s28, s67, 16
    v_mfma_f32_32x32x16_bf16 v[184:199], v[148:151], v[24:27], v[184:199]
    ds_read_b64_tr_b16 v[136:137], v152 offset:4096
    ds_read_b64_tr_b16 v[138:139], v152 offset:5120
    s_add_u32 s36, s30, 98304
    buffer_load_dwordx4 v[72:75], v8, s[4:7], s36 offen sc1
    s_add_u32 s27, s27, s28
    v_mfma_f32_32x32x16_bf16 v[168:183], v[144:147], v[24:27], v[168:183]
    buffer_load_dwordx4 v[76:79], v9, s[4:7], s36 offen sc1
    s_lshl_b32 s28, s78, 7
    s_waitcnt vmcnt(14)
    s_waitcnt lgkmcnt(0)
    v_mfma_f32_32x32x16_bf16 v[216:231], v[140:143], v[44:47], v[216:231]
    ds_write_b128 v15, v[88:91] offset:16384
    ds_write_b128 v15, v[92:95] offset:17408
    s_add_u32 s36, s30, 106496
    buffer_load_dwordx4 v[32:35], v8, s[4:7], s36 offen sc1
    s_add_u32 s27, s27, s28
    v_mfma_f32_32x32x16_bf16 v[200:215], v[136:139], v[44:47], v[200:215]
    ds_read_b64_tr_b16 v[148:149], v153 offset:16384
    ds_read_b64_tr_b16 v[150:151], v153 offset:17408
    buffer_load_dwordx4 v[36:39], v9, s[4:7], s36 offen sc1
    s_lshl_b32 s28, s66, 6
    v_mfma_f32_32x32x16_bf16 v[184:199], v[140:143], v[40:43], v[184:199]
    ds_read_b64_tr_b16 v[144:145], v152 offset:16384
    ds_read_b64_tr_b16 v[146:147], v152 offset:17408
    s_add_u32 s37, s73, 1114112
    buffer_load_dwordx4 v[80:83], v20, s[52:55], s37 offen
    s_add_u32 s27, s27, s28
    v_mfma_f32_32x32x16_bf16 v[168:183], v[136:139], v[40:43], v[168:183]
    buffer_load_dwordx4 v[84:87], v21, s[52:55], s37 offen offset:1024
    s_add_u32 s27, s27, 3145728
    s_waitcnt vmcnt(16)
    s_waitcnt lgkmcnt(0)
    v_mfma_f32_32x32x16_bf16 v[216:231], v[148:151], v[52:55], v[216:231]
    ds_write_b128 v15, v[96:99] offset:4096
    ds_write_b128 v15, v[100:103] offset:5120
    s_add_u32 s37, s73, 1245184
    buffer_load_dwordx4 v[24:27], v20, s[52:55], s37 offen
    v_add_u32 v18, s71, v22
    v_mfma_f32_32x32x16_bf16 v[200:215], v[144:147], v[52:55], v[200:215]
    ds_read_b64_tr_b16 v[140:141], v153 offset:4096
    ds_read_b64_tr_b16 v[142:143], v153 offset:5120
    buffer_load_dwordx4 v[28:31], v21, s[52:55], s37 offen offset:1024
    v_and_b32 v6, 15, v1
    v_mfma_f32_32x32x16_bf16 v[184:199], v[148:151], v[48:51], v[184:199]
    ds_read_b64_tr_b16 v[136:137], v152 offset:4096
    ds_read_b64_tr_b16 v[138:139], v152 offset:5120
    s_add_u32 s37, s73, 1376256
    buffer_load_dwordx4 v[88:91], v20, s[52:55], s37 offen
    v_bfe_u32 v7, v1, 4, 1
    v_mfma_f32_32x32x16_bf16 v[168:183], v[144:147], v[48:51], v[168:183]
    buffer_load_dwordx4 v[92:95], v21, s[52:55], s37 offen offset:1024
    v_lshl_add_u32 v6, v7, 5, v6
    s_waitcnt vmcnt(18)
    s_waitcnt lgkmcnt(0)
    v_mfma_f32_32x32x16_bf16 v[216:231], v[140:143], v[236:239], v[216:231]
    ds_write_b128 v15, v[104:107] offset:16384
    ds_write_b128 v15, v[108:111] offset:17408
    s_add_u32 s37, s73, 1507328
    buffer_load_dwordx4 v[40:43], v20, s[52:55], s37 offen
    s_lshl_b32 s28, s79, 6
    v_mfma_f32_32x32x16_bf16 v[200:215], v[136:139], v[236:239], v[200:215]
    ds_read_b64_tr_b16 v[148:149], v153 offset:16384
    ds_read_b64_tr_b16 v[150:151], v153 offset:17408
    buffer_load_dwordx4 v[44:47], v21, s[52:55], s37 offen offset:1024
    s_lshl_b32 s29, s67, 4
    v_mfma_f32_32x32x16_bf16 v[184:199], v[140:143], v[232:235], v[184:199]
    ds_read_b64_tr_b16 v[144:145], v152 offset:16384
    ds_read_b64_tr_b16 v[146:147], v152 offset:17408
    s_add_u32 s37, s73, 1638400
    buffer_load_dwordx4 v[96:99], v20, s[52:55], s37 offen
    s_add_u32 s28, s28, s29
    v_mfma_f32_32x32x16_bf16 v[168:183], v[136:139], v[232:235], v[168:183]
    buffer_load_dwordx4 v[100:103], v21, s[52:55], s37 offen offset:1024
    v_add_u32 v6, s28, v6
    s_waitcnt vmcnt(20)
    s_waitcnt lgkmcnt(0)
    v_mfma_f32_32x32x16_bf16 v[216:231], v[148:151], v[60:63], v[216:231]
    ds_write_b128 v15, v[112:115] offset:4096
    ds_write_b128 v15, v[116:119] offset:5120
    s_add_u32 s37, s73, 1769472
    buffer_load_dwordx4 v[48:51], v20, s[52:55], s37 offen
    s_lshr_b32 s28, s78, 4
    v_mfma_f32_32x32x16_bf16 v[200:215], v[144:147], v[60:63], v[200:215]
    ds_read_b64_tr_b16 v[140:141], v153 offset:4096
    ds_read_b64_tr_b16 v[142:143], v153 offset:5120
    buffer_load_dwordx4 v[52:55], v21, s[52:55], s37 offen offset:1024
    s_lshl_b32 s28, s28, 6
    v_mfma_f32_32x32x16_bf16 v[184:199], v[148:151], v[56:59], v[184:199]
    ds_read_b64_tr_b16 v[136:137], v152 offset:4096
    ds_read_b64_tr_b16 v[138:139], v152 offset:5120
    v_lshl_add_u32 v155, v6, 7, s28
    v_lshrrev_b32 v6, 5, v1
    v_lshlrev_b32 v6, 10, v6
    v_bfe_u32 v7, v1, 2, 2
    v_mfma_f32_32x32x16_bf16 v[168:183], v[144:147], v[56:59], v[168:183]
    v_lshl_add_u32 v6, v7, 6, v6
    v_bfe_u32 v7, v1, 4, 1
    v_lshl_add_u32 v6, v7, 5, v6
    v_and_b32 v7, 3, v1
    s_mov_b32 s65, 69632
    buffer_load_dwordx2 v[12:13], v154, s[4:7], s65 offen sc1
    s_waitcnt vmcnt(21)
    s_waitcnt lgkmcnt(0)
    v_mfma_f32_32x32x16_bf16 v[216:231], v[140:143], v[244:247], v[216:231]
    ds_write_b128 v15, v[120:123] offset:16384
    ds_write_b128 v15, v[124:127] offset:17408
    v_lshl_add_u32 v6, v7, 3, v6
    v_add_u32 v19, s71, v6
    v_mfma_f32_32x32x16_bf16 v[200:215], v[136:139], v[244:247], v[200:215]
    ds_read_b64_tr_b16 v[148:149], v153 offset:16384
    ds_read_b64_tr_b16 v[150:151], v153 offset:17408
    v_mfma_f32_32x32x16_bf16 v[184:199], v[140:143], v[240:243], v[184:199]
    ds_read_b64_tr_b16 v[144:145], v152 offset:16384
    ds_read_b64_tr_b16 v[146:147], v152 offset:17408
    v_mfma_f32_32x32x16_bf16 v[168:183], v[136:139], v[240:243], v[168:183]
    s_waitcnt vmcnt(19)
    s_waitcnt lgkmcnt(0)
    v_mfma_f32_32x32x16_bf16 v[216:231], v[148:151], v[68:71], v[216:231]
    ds_write_b128 v15, v[128:131] offset:4096
    ds_write_b128 v15, v[132:135] offset:5120
    buffer_load_dwordx4 v[232:235], v16, s[8:11], s26 offen
    v_mfma_f32_32x32x16_bf16 v[200:215], v[144:147], v[68:71], v[200:215]
    ds_read_b64_tr_b16 v[140:141], v153 offset:4096
    ds_read_b64_tr_b16 v[142:143], v153 offset:5120
    buffer_load_dwordx4 v[236:239], v16, s[8:11], s26 offen offset:16
    v_mfma_f32_32x32x16_bf16 v[184:199], v[148:151], v[64:67], v[184:199]
    ds_read_b64_tr_b16 v[136:137], v152 offset:4096
    ds_read_b64_tr_b16 v[138:139], v152 offset:5120
    global_load_dwordx4 v[112:115], v14, s[42:43]
    v_mfma_f32_32x32x16_bf16 v[168:183], v[144:147], v[64:67], v[168:183]
    global_load_dwordx4 v[116:119], v14, s[42:43] offset:16
    s_mov_b32 s69, 0
L_a_hpoll1:
    s_waitcnt vmcnt(4)
    v_xor_b32 v4, s50, v12
    v_xor_b32 v5, s51, v13
    v_or_b32 v4, v4, v5
    v_cmp_ne_u32 vcc, 0, v4
    s_add_u32 s69, s69, 1
    s_cmp_eq_u64 vcc, 0
    s_cbranch_scc1 L_a_hok1
    s_cmp_ge_u32 s69, 200000
    s_cbranch_scc1 L_a_hok1
    s_mov_b32 s65, 69632
    s_sleep 1
    buffer_load_dwordx2 v[12:13], v154, s[4:7], s65 offen sc1
    s_waitcnt vmcnt(0)
    s_branch L_a_hpoll1
L_a_hok1:
    s_add_u32 s36, s30, 4096
    buffer_load_dwordx4 v[56:59], v8, s[4:7], s36 offen sc1
    buffer_load_dwordx4 v[60:63], v9, s[4:7], s36 offen sc1
    s_add_u32 s36, s30, 12288
    buffer_load_dwordx4 v[120:123], v8, s[4:7], s36 offen sc1
    buffer_load_dwordx4 v[124:127], v9, s[4:7], s36 offen sc1
    s_add_u32 s36, s30, 20480
    buffer_load_dwordx4 v[240:243], v8, s[4:7], s36 offen sc1
    buffer_load_dwordx4 v[244:247], v9, s[4:7], s36 offen sc1
    s_add_u32 s36, s30, 28672
    buffer_load_dwordx4 v[128:131], v8, s[4:7], s36 offen sc1
    buffer_load_dwordx4 v[132:135], v9, s[4:7], s36 offen sc1
    s_waitcnt lgkmcnt(0)
    v_mfma_f32_32x32x16_bf16 v[216:231], v[140:143], v[252:255], v[216:231]
    s_add_u32 s36, s30, 36864
    buffer_load_dwordx4 v[64:67], v8, s[4:7], s36 offen sc1
    v_mfma_f32_32x32x16_bf16 v[200:215], v[136:139], v[252:255], v[200:215]
    ds_read_b64_tr_b16 v[148:149], v153 offset:6144
    ds_read_b64_tr_b16 v[150:151], v153 offset:7168
    buffer_load_dwordx4 v[68:71], v9, s[4:7], s36 offen sc1
    v_mfma_f32_32x32x16_bf16 v[184:199], v[140:143], v[248:251], v[184:199]
    ds_read_b64_tr_b16 v[144:145], v152 offset:6144
    ds_read_b64_tr_b16 v[146:147], v152 offset:7168
    v_mfma_f32_32x32x16_bf16 v[168:183], v[136:139], v[248:251], v[168:183]
    s_waitcnt lgkmcnt(0)
    v_mfma_f32_32x32x16_bf16 v[216:231], v[148:151], v[76:79], v[216:231]
    s_add_u32 s36, s30, 45056
    buffer_load_dwordx4 v[248:251], v8, s[4:7], s36 offen sc1
    v_mfma_f32_32x32x16_bf16 v[200:215], v[144:147], v[76:79], v[200:215]
    ds_read_b64_tr_b16 v[140:141], v153 offset:18432
    ds_read_b64_tr_b16 v[142:143], v153 offset:19456
    buffer_load_dwordx4 v[252:255], v9, s[4:7], s36 offen sc1
    v_mfma_f32_32x32x16_bf16 v[184:199], v[148:151], v[72:75], v[184:199]
    ds_read_b64_tr_b16 v[136:137], v152 offset:18432
    ds_read_b64_tr_b16 v[138:139], v152 offset:19456
    s_add_u32 m0, s71, 6144
    s_add_u32 s35, s73, 851968
    buffer_load_dwordx4 v20, s[52:55], s35 offen lds
    v_mfma_f32_32x32x16_bf16 v[168:183], v[144:147], v[72:75], v[168:183]
    buffer_load_dwordx4 v21, s[52:55], s35 offen offset:1024 lds
    s_waitcnt lgkmcnt(0)
    v_mfma_f32_32x32x16_bf16 v[216:231], v[140:143], v[36:39], v[216:231]
    s_add_u32 s36, s30, 53248
    buffer_load_dwordx4 v[72:75], v8, s[4:7], s36 offen sc1
    v_mfma_f32_32x32x16_bf16 v[200:215], v[136:139], v[36:39], v[200:215]
    ds_read_b64_tr_b16 v[148:149], v153 offset:8192
    ds_read_b64_tr_b16 v[150:151], v153 offset:9216
    buffer_load_dwordx4 v[76:79], v9, s[4:7], s36 offen sc1
    v_mfma_f32_32x32x16_bf16 v[184:199], v[140:143], v[32:35], v[184:199]
    ds_read_b64_tr_b16 v[144:145], v152 offset:8192
    ds_read_b64_tr_b16 v[146:147], v152 offset:9216
    s_add_u32 m0, s71, 18432
    s_add_u32 s35, s73, 983040
    buffer_load_dwordx4 v20, s[52:55], s35 offen lds
    v_mfma_f32_32x32x16_bf16 v[168:183], v[136:139], v[32:35], v[168:183]
    buffer_load_dwordx4 v21, s[52:55], s35 offen offset:1024 lds
    s_waitcnt vmcnt(16)
    s_waitcnt lgkmcnt(0)
    v_mfma_f32_32x32x16_bf16 v[216:231], v[148:151], v[60:63], v[216:231]
    s_add_u32 s36, s30, 61440
    buffer_load_dwordx4 v[32:35], v8, s[4:7], s36 offen sc1
    v_mfma_f32_32x32x16_bf16 v[200:215], v[144:147], v[60:63], v[200:215]
    ds_read_b64_tr_b16 v[140:141], v153 offset:10240
    ds_read_b64_tr_b16 v[142:143], v153 offset:11264
    buffer_load_dwordx4 v[36:39], v9, s[4:7], s36 offen sc1
    v_mfma_f32_32x32x16_bf16 v[184:199], v[148:151], v[56:59], v[184:199]
    ds_read_b64_tr_b16 v[136:137], v152 offset:10240
    ds_read_b64_tr_b16 v[138:139], v152 offset:11264
    v_mfma_f32_32x32x16_bf16 v[168:183], v[144:147], v[56:59], v[168:183]
    v_lshlrev_b32 v6, 16, v112
    v_and_b32 v7, 0xffff0000, v112
    s_nop 9
    v_add_f32 v168, v168, v6
    v_add_f32 v169, v169, v7
    v_lshlrev_b32 v6, 16, v113
    v_and_b32 v7, 0xffff0000, v113
    v_add_f32 v170, v170, v6
    v_add_f32 v171, v171, v7
    v_lshlrev_b32 v6, 16, v114
    v_and_b32 v7, 0xffff0000, v114
    v_add_f32 v172, v172, v6
    v_add_f32 v173, v173, v7
    v_lshlrev_b32 v6, 16, v115
    v_and_b32 v7, 0xffff0000, v115
    v_add_f32 v174, v174, v6
    v_add_f32 v175, v175, v7
    v_lshlrev_b32 v6, 16, v116
    v_and_b32 v7, 0xffff0000, v116
    v_add_f32 v176, v176, v6
    v_add_f32 v177, v177, v7
    v_lshlrev_b32 v6, 16, v117
    v_and_b32 v7, 0xffff0000, v117
    v_add_f32 v178, v178, v6
    v_add_f32 v179, v179, v7
    v_lshlrev_b32 v6, 16, v118
    v_and_b32 v7, 0xffff0000, v118
    v_add_f32 v180, v180, v6
    v_add_f32 v181, v181, v7
    v_lshlrev_b32 v6, 16, v119
    v_and_b32 v7, 0xffff0000, v119
    v_add_f32 v182, v182, v6
    v_add_f32 v183, v183, v7
    s_waitcnt vmcnt(16)
    s_waitcnt lgkmcnt(0)
    v_mfma_f32_32x32x16_bf16 v[216:231], v[140:143], v[124:127], v[216:231]
    s_add_u32 s36, s30, 69632
    buffer_load_dwordx4 v[56:59], v8, s[4:7], s36 offen sc1
    v_mfma_f32_32x32x16_bf16 v[200:215], v[136:139], v[124:127], v[200:215]
    ds_read_b64_tr_b16 v[148:149], v153 offset:12288
    ds_read_b64_tr_b16 v[150:151], v153 offset:13312
    buffer_load_dwordx4 v[60:63], v9, s[4:7], s36 offen sc1
    v_mfma_f32_32x32x16_bf16 v[184:199], v[140:143], v[120:123], v[184:199]
    ds_read_b64_tr_b16 v[144:145], v152 offset:12288
    ds_read_b64_tr_b16 v[146:147], v152 offset:13312
    v_mfma_f32_32x32x16_bf16 v[168:183], v[136:139], v[120:123], v[168:183]
    s_waitcnt vmcnt(16)
    s_waitcnt lgkmcnt(0)
    v_mfma_f32_32x32x16_bf16 v[216:231], v[148:151], v[244:247], v[216:231]
    s_add_u32 s36, s30, 77824
    buffer_load_dwordx4 v[112:115], v8, s[4:7], s36 offen sc1
    v_mfma_f32_32x32x16_bf16 v[200:215], v[144:147], v[244:247], v[200:215]
    ds_read_b64_tr_b16 v[140:141], v153 offset:0
    ds_read_b64_tr_b16 v[142:143], v153 offset:1024
    buffer_load_dwordx4 v[116:119], v9, s[4:7], s36 offen sc1
    v_mfma_f32_32x32x16_bf16 v[184:199], v[148:151], v[240:243], v[184:199]
    ds_read_b64_tr_b16 v[136:137], v152 offset:0
    ds_read_b64_tr_b16 v[138:139], v152 offset:1024
    s_add_u32 s36, s30, 86016
    buffer_load_dwordx4 v[120:123], v8, s[4:7], s36 offen sc1
    v_mfma_f32_32x32x16_bf16 v[168:183], v[144:147], v[240:243], v[168:183]
    buffer_load_dwordx4 v[124:127], v9, s[4:7], s36 offen sc1
    s_waitcnt vmcnt(18)
    s_waitcnt lgkmcnt(0)
    v_mfma_f32_32x32x16_bf16 v[216:231], v[140:143], v[132:135], v[216:231]
    s_add_u32 s36, s30, 94208
    buffer_load_dwordx4 v[240:243], v8, s[4:7], s36 offen sc1
    v_mfma_f32_32x32x16_bf16 v[200:215], v[136:139], v[132:135], v[200:215]
    ds_read_b64_tr_b16 v[148:149], v153 offset:2048
    ds_read_b64_tr_b16 v[150:151], v153 offset:3072
    buffer_load_dwordx4 v[244:247], v9, s[4:7], s36 offen sc1
    v_mfma_f32_32x32x16_bf16 v[184:199], v[140:143], v[128:131], v[184:199]
    ds_read_b64_tr_b16 v[144:145], v152 offset:2048
    ds_read_b64_tr_b16 v[146:147], v152 offset:3072
    v_mfma_f32_32x32x16_bf16 v[168:183], v[136:139], v[128:131], v[168:183]
    s_waitcnt vmcnt(18)
    s_waitcnt lgkmcnt(0)
    v_mfma_f32_32x32x16_bf16 v[216:231], v[148:151], v[68:71], v[216:231]
    s_add_u32 s36, s30, 102400
    buffer_load_dwordx4 v[128:131], v8, s[4:7], s36 offen sc1
    v_mfma_f32_32x32x16_bf16 v[200:215], v[144:147], v[68:71], v[200:215]
    ds_read_b64_tr_b16 v[140:141], v153 offset:14336
    ds_read_b64_tr_b16 v[142:143], v153 offset:15360
    buffer_load_dwordx4 v[132:135], v9, s[4:7], s36 offen sc1
    v_mfma_f32_32x32x16_bf16 v[184:199], v[148:151], v[64:67], v[184:199]
    ds_read_b64_tr_b16 v[136:137], v152 offset:14336
    ds_read_b64_tr_b16 v[138:139], v152 offset:15360
    v_mfma_f32_32x32x16_bf16 v[168:183], v[144:147], v[64:67], v[168:183]
    s_waitcnt vmcnt(18)
    s_waitcnt lgkmcnt(0)
    v_mfma_f32_32x32x16_bf16 v[216:231], v[140:143], v[252:255], v[216:231]
    s_waitcnt vmcnt(16)
    s_add_u32 s36, s30, 110592
    buffer_load_dwordx4 v[64:67], v8, s[4:7], s36 offen sc1
    v_mfma_f32_32x32x16_bf16 v[200:215], v[136:139], v[252:255], v[200:215]
    ds_read_b64_tr_b16 v[148:149], v153 offset:6144
    ds_read_b64_tr_b16 v[150:151], v153 offset:7168
    buffer_load_dwordx4 v[68:71], v9, s[4:7], s36 offen sc1
    v_mfma_f32_32x32x16_bf16 v[184:199], v[140:143], v[248:251], v[184:199]
    ds_read_b64_tr_b16 v[144:145], v152 offset:6144
    ds_read_b64_tr_b16 v[146:147], v152 offset:7168
    v_mfma_f32_32x32x16_bf16 v[168:183], v[136:139], v[248:251], v[168:183]
    s_waitcnt vmcnt(16)
    s_waitcnt lgkmcnt(0)
    v_mfma_f32_32x32x16_bf16 v[216:231], v[148:151], v[76:79], v[216:231]
    s_waitcnt vmcnt(14)
    v_mfma_f32_32x32x16_bf16 v[200:215], v[144:147], v[76:79], v[200:215]
    ds_read_b64_tr_b16 v[140:141], v153 offset:18432
    ds_read_b64_tr_b16 v[142:143], v153 offset:19456
    v_mfma_f32_32x32x16_bf16 v[184:199], v[148:151], v[72:75], v[184:199]
    ds_read_b64_tr_b16 v[136:137], v152 offset:18432
    ds_read_b64_tr_b16 v[138:139], v152 offset:19456
    v_mfma_f32_32x32x16_bf16 v[168:183], v[144:147], v[72:75], v[168:183]
    s_waitcnt vmcnt(12)
    s_waitcnt lgkmcnt(0)
    v_mfma_f32_32x32x16_bf16 v[216:231], v[140:143], v[36:39], v[216:231]
    ds_write_b128 v15, v[80:83] offset:16384
    ds_write_b128 v15, v[84:87] offset:17408
    v_mfma_f32_32x32x16_bf16 v[200:215], v[136:139], v[36:39], v[200:215]
    ds_read_b64_tr_b16 v[148:149], v153 offset:16384
    ds_read_b64_tr_b16 v[150:151], v153 offset:17408
    v_mfma_f32_32x32x16_bf16 v[184:199], v[140:143], v[32:35], v[184:199]
    ds_read_b64_tr_b16 v[144:145], v152 offset:16384
    ds_read_b64_tr_b16 v[146:147], v152 offset:17408
    v_mfma_f32_32x32x16_bf16 v[168:183], v[136:139], v[32:35], v[168:183]
    s_waitcnt vmcnt(10)
    s_waitcnt lgkmcnt(0)
    v_mfma_f32_32x32x16_bf16 v[216:231], v[148:151], v[60:63], v[216:231]
    ds_write_b128 v15, v[24:27] offset:4096
    ds_write_b128 v15, v[28:31] offset:5120
    v_mfma_f32_32x32x16_bf16 v[200:215], v[144:147], v[60:63], v[200:215]
    ds_read_b64_tr_b16 v[140:141], v153 offset:4096
    ds_read_b64_tr_b16 v[142:143], v153 offset:5120
    v_mfma_f32_32x32x16_bf16 v[184:199], v[148:151], v[56:59], v[184:199]
    ds_read_b64_tr_b16 v[136:137], v152 offset:4096
    ds_read_b64_tr_b16 v[138:139], v152 offset:5120
    v_mfma_f32_32x32x16_bf16 v[168:183], v[144:147], v[56:59], v[168:183]
    s_mov_b32 s65, 458752
    buffer_load_dwordx2 v[12:13], v155, s[4:7], s65 offen sc1
    s_waitcnt vmcnt(9)
    s_waitcnt lgkmcnt(0)
    v_mfma_f32_32x32x16_bf16 v[216:231], v[140:143], v[116:119], v[216:231]
    ds_write_b128 v15, v[88:91] offset:16384
    ds_write_b128 v15, v[92:95] offset:17408
    v_mfma_f32_32x32x16_bf16 v[200:215], v[136:139], v[116:119], v[200:215]
    ds_read_b64_tr_b16 v[148:149], v153 offset:16384
    ds_read_b64_tr_b16 v[150:151], v153 offset:17408
    v_mfma_f32_32x32x16_bf16 v[184:199], v[140:143], v[112:115], v[184:199]
    ds_read_b64_tr_b16 v[144:145], v152 offset:16384
    ds_read_b64_tr_b16 v[146:147], v152 offset:17408
    v_mfma_f32_32x32x16_bf16 v[168:183], v[136:139], v[112:115], v[168:183]
    s_waitcnt vmcnt(7)
    s_waitcnt lgkmcnt(0)
    v_mfma_f32_32x32x16_bf16 v[216:231], v[148:151], v[124:127], v[216:231]
    ds_write_b128 v15, v[40:43] offset:4096
    ds_write_b128 v15, v[44:47] offset:5120
    v_mfma_f32_32x32x16_bf16 v[200:215], v[144:147], v[124:127], v[200:215]
    ds_read_b64_tr_b16 v[140:141], v153 offset:4096
    ds_read_b64_tr_b16 v[142:143], v153 offset:5120
    v_mfma_f32_32x32x16_bf16 v[184:199], v[148:151], v[120:123], v[184:199]
    ds_read_b64_tr_b16 v[136:137], v152 offset:4096
    ds_read_b64_tr_b16 v[138:139], v152 offset:5120
    v_mfma_f32_32x32x16_bf16 v[168:183], v[144:147], v[120:123], v[168:183]
    s_waitcnt vmcnt(5)
    s_waitcnt lgkmcnt(0)
    v_mfma_f32_32x32x16_bf16 v[216:231], v[140:143], v[244:247], v[216:231]
    ds_write_b128 v15, v[96:99] offset:16384
    ds_write_b128 v15, v[100:103] offset:17408
    v_lshlrev_b32 v248, 16, v232
    v_and_b32 v249, 0xffff0000, v232
    v_lshlrev_b32 v250, 16, v233
    v_and_b32 v251, 0xffff0000, v233
    v_mfma_f32_32x32x16_bf16 v[200:215], v[136:139], v[244:247], v[200:215]
    ds_read_b64_tr_b16 v[148:149], v153 offset:16384
    ds_read_b64_tr_b16 v[150:151], v153 offset:17408
    v_lshlrev_b32 v252, 16, v234
    v_and_b32 v253, 0xffff0000, v234
    v_lshlrev_b32 v254, 16, v235
    v_and_b32 v255, 0xffff0000, v235
    v_mfma_f32_32x32x16_bf16 v[184:199], v[140:143], v[240:243], v[184:199]
    ds_read_b64_tr_b16 v[144:145], v152 offset:16384
    ds_read_b64_tr_b16 v[146:147], v152 offset:17408
    v_lshlrev_b32 v72, 16, v236
    v_and_b32 v73, 0xffff0000, v236
    v_lshlrev_b32 v74, 16, v237
    v_and_b32 v75, 0xffff0000, v237
    v_mfma_f32_32x32x16_bf16 v[168:183], v[136:139], v[240:243], v[168:183]
    v_lshlrev_b32 v76, 16, v238
    v_and_b32 v77, 0xffff0000, v238
    v_lshlrev_b32 v78, 16, v239
    v_and_b32 v79, 0xffff0000, v239
    s_waitcnt vmcnt(0)
    v_xor_b32 v4, s50, v12
    v_xor_b32 v5, s51, v13
    v_or_b32 v4, v4, v5
    v_cmp_ne_u32 s[74:75], 0, v4
    s_add_u32 s65, s27, 0
    buffer_load_dwordx4 v[104:107], v17, s[4:7], s65 offen sc1
    s_add_u32 s65, s27, 131072
    buffer_load_dwordx4 v[108:111], v17, s[4:7], s65 offen sc1
    s_waitcnt lgkmcnt(0)
    v_mfma_f32_32x32x16_bf16 v[216:231], v[148:151], v[132:135], v[216:231]
    ds_write_b128 v15, v[48:51] offset:4096
    ds_write_b128 v15, v[52:55] offset:5120
    v_mfma_f32_32x32x16_bf16 v[200:215], v[144:147], v[132:135], v[200:215]
    ds_read_b64_tr_b16 v[140:141], v153 offset:4096
    ds_read_b64_tr_b16 v[142:143], v153 offset:5120
    v_mfma_f32_32x32x16_bf16 v[184:199], v[148:151], v[128:131], v[184:199]
    ds_read_b64_tr_b16 v[136:137], v152 offset:4096
    ds_read_b64_tr_b16 v[138:139], v152 offset:5120
    v_mfma_f32_32x32x16_bf16 v[168:183], v[144:147], v[128:131], v[168:183]
    s_waitcnt lgkmcnt(0)
    v_mfma_f32_32x32x16_bf16 v[216:231], v[140:143], v[68:71], v[216:231]
    v_mfma_f32_32x32x16_bf16 v[200:215], v[136:139], v[68:71], v[200:215]
    v_mfma_f32_32x32x16_bf16 v[184:199], v[140:143], v[64:67], v[184:199]
    v_mfma_f32_32x32x16_bf16 v[168:183], v[136:139], v[64:67], v[168:183]
    v_add_u32 v5, s71, v22
    s_nop 7
    ds_write_b128 v5, v[216:219] offset:12288
    ds_write_b128 v5, v[220:223] offset:13312
    ds_write_b128 v5, v[224:227] offset:14336
    ds_write_b128 v5, v[228:231] offset:15360
    ds_write_b128 v5, v[200:203] offset:8192
    ds_write_b128 v5, v[204:207] offset:9216
    ds_write_b128 v5, v[208:211] offset:10240
    ds_write_b128 v5, v[212:215] offset:11264
    ds_write_b128 v5, v[184:187] offset:4096
    ds_write_b128 v5, v[188:191] offset:5120
    ds_write_b128 v5, v[192:195] offset:6144
    ds_write_b128 v5, v[196:199] offset:7168
    s_waitcnt vmcnt(0)
    ds_write_b128 v18, v[104:107] offset:0
    ds_write_b128 v18, v[108:111] offset:1024
    ds_read_b64_tr_b16 v[80:81], v19 offset:0
    ds_read_b64_tr_b16 v[82:83], v19 offset:256
    ds_read_b64_tr_b16 v[84:85], v19 offset:512
    ds_read_b64_tr_b16 v[86:87], v19 offset:768
    s_xor_b32 s65, s3, 1
    s_mul_i32 s65, s65, 20480
    v_add_u32 v5, s65, v22
    s_xor_b32 s65, s3, 2
    s_mul_i32 s65, s65, 20480
    v_add_u32 v6, s65, v22
    s_xor_b32 s65, s3, 3
    s_mul_i32 s65, s65, 20480
    v_add_u32 v7, s65, v22
    s_waitcnt lgkmcnt(0)
    s_barrier
    ds_read_b128 v[184:187], v5 offset:4096
    ds_read_b128 v[188:191], v5 offset:5120
    ds_read_b128 v[192:195], v5 offset:6144
    ds_read_b128 v[196:199], v5 offset:7168
    ds_read_b128 v[200:203], v6 offset:8192
    ds_read_b128 v[204:207], v6 offset:9216
    ds_read_b128 v[208:211], v6 offset:10240
    ds_read_b128 v[212:215], v6 offset:11264
    ds_read_b128 v[216:219], v7 offset:12288
    ds_read_b128 v[220:223], v7 offset:13312
    ds_read_b128 v[224:227], v7 offset:14336
    ds_read_b128 v[228:231], v7 offset:15360
    v_lshlrev_b32 v88, 16, v80
    v_and_b32 v89, 0xffff0000, v80
    v_lshlrev_b32 v90, 16, v81
    v_and_b32 v91, 0xffff0000, v81
    v_lshlrev_b32 v92, 16, v82
    v_and_b32 v93, 0xffff0000, v82
    v_lshlrev_b32 v94, 16, v83
    v_and_b32 v95, 0xffff0000, v83
    v_lshlrev_b32 v112, 16, v84
    v_and_b32 v113, 0xffff0000, v84
    v_lshlrev_b32 v114, 16, v85
    v_and_b32 v115, 0xffff0000, v85
    v_lshlrev_b32 v116, 16, v86
    v_and_b32 v117, 0xffff0000, v86
    v_lshlrev_b32 v118, 16, v87
    v_and_b32 v119, 0xffff0000, v87
    s_waitcnt lgkmcnt(8)
    v_add_f32 v168, v168, v184
    v_add_f32 v169, v169, v185
    v_add_f32 v170, v170, v186
    v_add_f32 v171, v171, v187
    v_add_f32 v172, v172, v188
    v_add_f32 v173, v173, v189
    v_add_f32 v174, v174, v190
    v_add_f32 v175, v175, v191
    v_add_f32 v176, v176, v192
    v_add_f32 v177, v177, v193
    v_add_f32 v178, v178, v194
    v_add_f32 v179, v179, v195
    v_add_f32 v180, v180, v196
    v_add_f32 v181, v181, v197
    v_add_f32 v182, v182, v198
    v_add_f32 v183, v183, v199
    s_waitcnt lgkmcnt(4)
    v_add_f32 v168, v168, v200
    v_add_f32 v169, v169, v201
    v_add_f32 v170, v170, v202
    v_add_f32 v171, v171, v203
    v_add_f32 v172, v172, v204
    v_add_f32 v173, v173, v205
    v_add_f32 v174, v174, v206
    v_add_f32 v175, v175, v207
    v_add_f32 v176, v176, v208
    v_add_f32 v177, v177, v209
    v_add_f32 v178, v178, v210
    v_add_f32 v179, v179, v211
    v_add_f32 v180, v180, v212
    v_add_f32 v181, v181, v213
    v_add_f32 v182, v182, v214
    v_add_f32 v183, v183, v215
    s_waitcnt lgkmcnt(0)
    v_add_f32 v168, v168, v216
    v_add_f32 v169, v169, v217
    v_add_f32 v170, v170, v218
    v_add_f32 v171, v171, v219
    v_add_f32 v172, v172, v220
    v_add_f32 v173, v173, v221
    v_add_f32 v174, v174, v222
    v_add_f32 v175, v175, v223
    v_add_f32 v176, v176, v224
    v_add_f32 v177, v177, v225
    v_add_f32 v178, v178, v226
    v_add_f32 v179, v179, v227
    v_add_f32 v180, v180, v228
    v_add_f32 v181, v181, v229
    v_add_f32 v182, v182, v230
    v_add_f32 v183, v183, v231
    v_mul_f32 v24, 0xbfb8aa3b, v168
    v_mul_f32 v25, 0xbfb8aa3b, v169
    v_mul_f32 v26, 0xbfb8aa3b, v170
    v_mul_f32 v27, 0xbfb8aa3b, v171
    v_mul_f32 v28, 0xbfb8aa3b, v172
    v_mul_f32 v29, 0xbfb8aa3b, v173
    v_mul_f32 v30, 0xbfb8aa3b, v174
    v_mul_f32 v31, 0xbfb8aa3b, v175
    v_mul_f32 v56, 0xbfb8aa3b, v176
    v_mul_f32 v57, 0xbfb8aa3b, v177
    v_mul_f32 v58, 0xbfb8aa3b, v178
    v_mul_f32 v59, 0xbfb8aa3b, v179
    v_mul_f32 v60, 0xbfb8aa3b, v180
    v_mul_f32 v61, 0xbfb8aa3b, v181
    v_mul_f32 v62, 0xbfb8aa3b, v182
    v_mul_f32 v63, 0xbfb8aa3b, v183
    v_exp_f32 v24, v24
    v_exp_f32 v25, v25
    v_exp_f32 v26, v26
    v_exp_f32 v27, v27
    v_exp_f32 v28, v28
    v_exp_f32 v29, v29
    v_exp_f32 v30, v30
    v_exp_f32 v31, v31
    v_exp_f32 v56, v56
    v_exp_f32 v57, v57
    v_exp_f32 v58, v58
    v_exp_f32 v59, v59
    v_exp_f32 v60, v60
    v_exp_f32 v61, v61
    v_exp_f32 v62, v62
    v_exp_f32 v63, v63
    v_add_f32 v24, 1.0, v24
    v_add_f32 v25, 1.0, v25
    v_add_f32 v26, 1.0, v26
    v_add_f32 v27, 1.0, v27
    v_add_f32 v28, 1.0, v28
    v_add_f32 v29, 1.0, v29
    v_add_f32 v30, 1.0, v30
    v_add_f32 v31, 1.0, v31
    v_add_f32 v56, 1.0, v56
    v_add_f32 v57, 1.0, v57
    v_add_f32 v58, 1.0, v58
    v_add_f32 v59, 1.0, v59
    v_add_f32 v60, 1.0, v60
    v_add_f32 v61, 1.0, v61
    v_add_f32 v62, 1.0, v62
    v_add_f32 v63, 1.0, v63
    v_rcp_f32 v24, v24
    v_rcp_f32 v25, v25
    v_rcp_f32 v26, v26
    v_rcp_f32 v27, v27
    v_rcp_f32 v28, v28
    v_rcp_f32 v29, v29
    v_rcp_f32 v30, v30
    v_rcp_f32 v31, v31
    v_rcp_f32 v56, v56
    v_rcp_f32 v57, v57
    v_rcp_f32 v58, v58
    v_rcp_f32 v59, v59
    v_rcp_f32 v60, v60
    v_rcp_f32 v61, v61
    v_rcp_f32 v62, v62
    v_rcp_f32 v63, v63
    v_mul_f32 v24, v168, v24
    v_mul_f32 v25, v169, v25
    v_mul_f32 v26, v170, v26
    v_mul_f32 v27, v171, v27
    v_mul_f32 v28, v172, v28
    v_mul_f32 v29, v173, v29
    v_mul_f32 v30, v174, v30
    v_mul_f32 v31, v175, v31
    v_mul_f32 v56, v176, v56
    v_mul_f32 v57, v177, v57
    v_mul_f32 v58, v178, v58
    v_mul_f32 v59, v179, v59
    v_mul_f32 v60, v180, v60
    v_mul_f32 v61, v181, v61
    v_mul_f32 v62, v182, v62
    v_mul_f32 v63, v183, v63
    s_cmp_eq_u64 s[74:75], 0
    s_cbranch_scc1 L_a_sfast
    s_mov_b32 s65, 458752
    buffer_load_dwordx2 v[12:13], v155, s[4:7], s65 offen sc1
    s_mov_b32 s69, 0
L_a_hpoll2:
    s_waitcnt vmcnt(0)
    v_xor_b32 v4, s50, v12
    v_xor_b32 v5, s51, v13
    v_or_b32 v4, v4, v5
    v_cmp_ne_u32 vcc, 0, v4
    s_add_u32 s69, s69, 1
    s_cmp_eq_u64 vcc, 0
    s_cbranch_scc1 L_a_hok2
    s_cmp_ge_u32 s69, 200000
    s_cbranch_scc1 L_a_hok2
    s_mov_b32 s65, 458752
    s_sleep 1
    buffer_load_dwordx2 v[12:13], v155, s[4:7], s65 offen sc1
    s_waitcnt vmcnt(0)
    s_branch L_a_hpoll2
L_a_hok2:
    s_add_u32 s65, s27, 0
    buffer_load_dwordx4 v[104:107], v17, s[4:7], s65 offen sc1
    s_add_u32 s65, s27, 131072
    buffer_load_dwordx4 v[108:111], v17, s[4:7], s65 offen sc1
    s_waitcnt vmcnt(0)
    ds_write_b128 v18, v[104:107] offset:0
    ds_write_b128 v18, v[108:111] offset:1024
    ds_read_b64_tr_b16 v[80:81], v19 offset:0
    ds_read_b64_tr_b16 v[82:83], v19 offset:256
    ds_read_b64_tr_b16 v[84:85], v19 offset:512
    ds_read_b64_tr_b16 v[86:87], v19 offset:768
    s_waitcnt lgkmcnt(0)
    v_lshlrev_b32 v88, 16, v80
    v_and_b32 v89, 0xffff0000, v80
    v_lshlrev_b32 v90, 16, v81
    v_and_b32 v91, 0xffff0000, v81
    v_lshlrev_b32 v92, 16, v82
    v_and_b32 v93, 0xffff0000, v82
    v_lshlrev_b32 v94, 16, v83
    v_and_b32 v95, 0xffff0000, v83
    v_lshlrev_b32 v112, 16, v84
    v_and_b32 v113, 0xffff0000, v84
    v_lshlrev_b32 v114, 16, v85
    v_and_b32 v115, 0xffff0000, v85
    v_lshlrev_b32 v116, 16, v86
    v_and_b32 v117, 0xffff0000, v86
    v_lshlrev_b32 v118, 16, v87
    v_and_b32 v119, 0xffff0000, v87
L_a_sfast:
    v_fma_f32 v168, v88, v24, v248
    v_fma_f32 v169, v89, v25, v249
    v_fma_f32 v170, v90, v26, v250
    v_fma_f32 v171, v91, v27, v251
    v_fma_f32 v172, v92, v28, v252
    v_fma_f32 v173, v93, v29, v253
    v_fma_f32 v174, v94, v30, v254
    v_fma_f32 v175, v95, v31, v255
    v_cvt_pk_bf16_f32 v32, v168, v169
    v_cvt_pk_bf16_f32 v33, v170, v171
    v_cvt_pk_bf16_f32 v34, v172, v173
    v_cvt_pk_bf16_f32 v35, v174, v175
    buffer_store_dwordx4 v[32:35], v16, s[56:59], s26 offen offset:0
    v_fma_f32 v176, v112, v56, v72
    v_fma_f32 v177, v113, v57, v73
    v_fma_f32 v178, v114, v58, v74
    v_fma_f32 v179, v115, v59, v75
    v_fma_f32 v180, v116, v60, v76
    v_fma_f32 v181, v117, v61, v77
    v_fma_f32 v182, v118, v62, v78
    v_fma_f32 v183, v119, v63, v79
    v_cvt_pk_bf16_f32 v36, v176, v177
    v_cvt_pk_bf16_f32 v37, v178, v179
    v_cvt_pk_bf16_f32 v38, v180, v181
    v_cvt_pk_bf16_f32 v39, v182, v183
    buffer_store_dwordx4 v[36:39], v16, s[56:59], s26 offen offset:16
    s_endpgm
L_exit:
    s_endpgm
.section .rodata,"a"
.p2align 6
.amdhsa_kernel recurrent_scan__ssm_conv_s4__mixer_channel_mlp__prompt_kernel
  .amdhsa_next_free_vgpr 256
  .amdhsa_next_free_sgpr 102
  .amdhsa_accum_offset 256
  .amdhsa_group_segment_fixed_size 0
  .amdhsa_kernarg_size 136
  .amdhsa_user_sgpr_count 2
  .amdhsa_user_sgpr_kernarg_segment_ptr 1
  .amdhsa_system_sgpr_workgroup_id_x 1
  .amdhsa_float_denorm_mode_32 3
  .amdhsa_float_denorm_mode_16_64 3
.end_amdhsa_kernel
```
